```python
import torch

def _softmax(x, axis=-1):
    return torch.softmax(x, dim=axis)
def _gelu(x):
    return torch.nn.functional.gelu(x, approximate="tanh")
def _silu(x):
    return torch.nn.functional.silu(x)
def _sigmoid(x):
    return torch.sigmoid(x)
def _layernorm(x, axis=-1, eps=1e-5):
    m = x.mean(dim=axis, keepdim=True)
    v = x.var(dim=axis, keepdim=True, unbiased=False)
    return (x - m) / torch.sqrt(v + eps)
def _scatter_add(tgt, idx, src, axis=0):
    return tgt.clone().index_add_(axis, idx, src)
def _segment_sum(src, seg, n):
    out = torch.zeros((n,) + src.shape[1:], dtype=src.dtype)
    return out.index_add_(0, seg, src)
def _pad(x, pw):
    flat = tuple(v for pair in reversed(pw) for v in pair)
    return torch.nn.functional.pad(x, flat)

kernel_name = 'gather_scatter__cheap_equivariant_egnn__graph'

def setup_inputs():

    _w = (lambda a: (lambda t: t.to(torch.bfloat16) if t.is_floating_point() else t)(torch.as_tensor(a)))
    N, deg, D, De = 12500, 64, 64, max(16, 1)
    E = N * deg
    return {
        "h": _w((lambda *s: torch.randn(*s, dtype=torch.bfloat16) * 0.1)(N, D)),
        "pos": _w((lambda *s: torch.randn(*s, dtype=torch.bfloat16) * 0.8)(N, 3)),
        "e_attr": _w((lambda *s: torch.randn(*s, dtype=torch.bfloat16) * 0.8)(E, De)),
        "src": _w((lambda lo, hi, *s: torch.randint(lo, hi, s))(0, N, E).to(torch.int64)),
        "dst": _w((lambda lo, hi, *s: torch.randint(lo, hi, s))(0, N, E).to(torch.int64)),
        "w_e": _w(0.1 * (lambda *s: torch.randn(*s, dtype=torch.bfloat16) * 0.8)(2 * D + 1 + De, D)),
        "w_x": _w(0.1 * (lambda *s: torch.randn(*s, dtype=torch.bfloat16) * 0.1)(D, 1)),
        "w_h": _w(0.1 * (lambda *s: torch.randn(*s, dtype=torch.bfloat16) * 0.1)(2 * D, D)),
    }

def reference(h, pos, e_attr, src, dst, w_e, w_x, w_h):
    N, D = h.shape[0], h.shape[1]
    diff = pos[dst] - pos[src]
    dist2 = torch.sum(diff * diff, axis=-1, keepdims=True)
    e_in = torch.concatenate([h[dst], h[src], dist2, e_attr], axis=-1)
    m_ij = _silu(e_in @ w_e)
    coord_scale = m_ij @ w_x
    pos_new = pos + _segment_sum(diff * coord_scale, dst, N)
    m_i = _segment_sum(m_ij, dst, N)
    h_new = h + _silu(torch.concatenate([h, m_i], axis=-1) @ w_h)
    return h_new, pos_new
```

```asm
; @launch grid=(256,1,1) block=(512,1,1) lds=160000
.amdgcn_target "amdgcn-amd-amdhsa--gfx950"
.text
.globl gather_scatter__cheap_equivariant_egnn__graph_kernel
.p2align 8
.type gather_scatter__cheap_equivariant_egnn__graph_kernel,@function
gather_scatter__cheap_equivariant_egnn__graph_kernel:
  s_cmp_ge_u32 s2, 256
  s_cbranch_scc1 K_END
  s_load_dwordx4 s[68:71], s[0:1], 16
  s_load_dwordx4 s[72:75], s[0:1], 32
  s_getpc_b64 s[84:85]
K_PC:
  s_lshr_b32 s46, s2, 3
  v_lshrrev_b32 v235, 6, v0
  s_and_b32 s46, s46, 31
  s_and_b32 s85, s85, 0xffff
  s_lshl_b32 s46, s46, 10
  s_mov_b32 s86, K_CODE_END-K_PC
  s_mov_b32 s87, 0x20000
  v_lshl_add_u32 v236, v235, 7, s46
  buffer_load_dword v245, v236, s[84:87], 0 offen
  v_and_b32 v1, 63, v0
  s_mul_i32 s46, s2, 12544
  v_mul_u32_u24 v237, 1536, v235
  v_readfirstlane_b32 s32, v235
  v_lshl_add_u32 v237, v1, 3, v237
  v_add_u32 v237, s46, v237
  s_waitcnt lgkmcnt(0)
  s_mov_b32 s28, s72
  s_and_b32 s29, s73, 0xffff
  s_mov_b32 s30, 3200000
  s_mov_b32 s31, 0x20000
  s_mov_b32 s24, s70
  s_and_b32 s25, s71, 0xffff
  s_mov_b32 s26, 3200000
  s_mov_b32 s27, 0x20000
  buffer_load_dwordx2 v[60:61], v237, s[28:31], 0 offen offset:0
  buffer_load_dwordx2 v[62:63], v237, s[28:31], 0 offen offset:512
  buffer_load_dwordx2 v[64:65], v237, s[28:31], 0 offen offset:1024
  buffer_load_dwordx2 v[68:69], v237, s[24:27], 0 offen offset:0
  buffer_load_dwordx2 v[70:71], v237, s[24:27], 0 offen offset:512
  buffer_load_dwordx2 v[72:73], v237, s[24:27], 0 offen offset:1024
  s_load_dwordx4 s[64:67], s[0:1], 0
  s_load_dwordx4 s[76:79], s[0:1], 64
  s_load_dwordx2 s[80:81], s[0:1], 80
  v_lshlrev_b32 v242, 4, v1
  v_lshrrev_b32 v237, 5, v1
  v_lshlrev_b32 v198, 4, v237
  v_mov_b32 v200, 0
  v_mov_b32 v201, 0
  s_lshl_b32 s46, s2, 3
  s_add_u32 s46, s46, s32
  s_mul_i32 s33, s46, 3125
  s_add_u32 s34, s33, 3636
  s_add_u32 s33, s33, 511
  s_lshr_b32 s33, s33, 9
  s_lshr_b32 s34, s34, 9
  s_sub_u32 s34, s34, s33
  s_mul_i32 s35, s33, 6
  s_waitcnt lgkmcnt(0)
  s_mov_b32 s92, s78
  s_and_b32 s93, s79, 0xffff
  s_mov_b32 s94, 256
  s_mov_b32 s95, 0x20000
  s_mov_b32 s12, s80
  s_and_b32 s13, s81, 0xffff
  s_mov_b32 s14, 10002432
  s_mov_b32 s15, 0x20000
  s_cmp_lg_u32 s32, 0
  s_cbranch_scc1 K_S_NOOLD
  s_lshl_b32 s46, s2, 4
  s_add_u32 s46, s46, 9990144
  buffer_load_dword v202, v200, s[12:15], s46 offen sc1
K_S_NOOLD:
  s_mov_b32 s84, s64
  s_and_b32 s85, s65, 0xffff
  s_mov_b32 s86, 1600000
  s_mov_b32 s87, 0x20000
  s_mov_b32 s48, s64
  s_and_b32 s49, s65, 0xffff
  s_mov_b32 s50, 1600000
  s_mov_b32 s51, 0x20000
  s_mov_b32 s88, s74
  s_and_b32 s89, s75, 0xffff
  s_mov_b32 s90, 18560
  s_mov_b32 s91, 0x20000
  s_cmp_eq_u32 s32, 7
  s_cbranch_scc1 K_S_W7
  s_cmp_eq_u32 s32, 4
  s_cbranch_scc1 K_S_W4
  s_cmp_lt_u32 s32, 5
  s_cbranch_scc1 K_S_COMMON
  s_sub_u32 s57, s32, 5
  s_lshl_b32 s58, s57, 13
  s_add_u32 s58, s58, 110848
  s_add_u32 s46, s58, 0
  s_mov_b32 m0, s46
  s_mov_b32 s47, 8192
  buffer_load_dwordx4 v242, s[88:91], s47 offen lds
  s_add_u32 s46, s58, 1024
  s_mov_b32 m0, s46
  s_mov_b32 s47, 9216
  buffer_load_dwordx4 v242, s[88:91], s47 offen lds
  s_add_u32 s46, s58, 2048
  s_mov_b32 m0, s46
  s_mov_b32 s47, 10240
  buffer_load_dwordx4 v242, s[88:91], s47 offen lds
  s_add_u32 s46, s58, 3072
  s_mov_b32 m0, s46
  s_mov_b32 s47, 11264
  buffer_load_dwordx4 v242, s[88:91], s47 offen lds
  s_add_u32 s46, s58, 4096
  s_mov_b32 m0, s46
  s_mov_b32 s47, 12288
  buffer_load_dwordx4 v242, s[88:91], s47 offen lds
  s_add_u32 s46, s58, 5120
  s_mov_b32 m0, s46
  s_mov_b32 s47, 13312
  buffer_load_dwordx4 v242, s[88:91], s47 offen lds
  s_add_u32 s46, s58, 6144
  s_mov_b32 m0, s46
  s_mov_b32 s47, 14336
  buffer_load_dwordx4 v242, s[88:91], s47 offen lds
  s_add_u32 s46, s58, 7168
  s_mov_b32 m0, s46
  s_mov_b32 s47, 15360
  buffer_load_dwordx4 v242, s[88:91], s47 offen lds
  s_mul_i32 s46, s2, 49
  s_lshl_b32 s47, s57, 5
  s_add_u32 s46, s46, s47
  v_and_b32 v235, 31, v1
  v_add_u32 v235, s46, v235
  v_lshl_add_u32 v235, v235, 7, v198
  buffer_load_dwordx4 v[92:95], v235, s[84:87], 0 offen offset:0
  buffer_load_dwordx4 v[96:99], v235, s[84:87], 0 offen offset:32
  buffer_load_dwordx4 v[100:103], v235, s[84:87], 0 offen offset:64
  buffer_load_dwordx4 v[104:107], v235, s[84:87], 0 offen offset:96
  s_branch K_S_COMMON
K_S_W4:
  s_load_dwordx2 s[82:83], s[0:1], 56
  s_mov_b32 s20, s66
  s_and_b32 s21, s67, 0xffff
  s_mov_b32 s22, 75000
  s_mov_b32 s23, 0x20000
  s_lshr_b32 s46, s2, 3
  s_and_b32 s46, s46, 31
  s_mul_i32 s47, s46, 2432
  v_lshlrev_b32 v235, 7, v1
  v_add_u32 v236, s47, v235
  v_cmp_gt_u32 vcc, 19, v1
  v_mov_b32 v237, 0x40000000
  s_waitcnt lgkmcnt(0)
  v_cndmask_b32 v236, v237, v236, vcc
  buffer_load_dword v245, v236, s[20:23], 0 offen
  s_mov_b32 s88, s82
  s_and_b32 s89, s83, 0xffff
  s_mov_b32 s90, 16384
  s_mov_b32 s91, 0x20000
  s_lshl_b32 s47, s46, 9
  v_add_u32 v236, s47, v235
  v_cmp_gt_u32 vcc, 4, v1
  s_nop 1
  v_cndmask_b32 v236, v237, v236, vcc
  buffer_load_dword v245, v236, s[88:91], 0 offen
  s_branch K_S_COMMON
K_S_W7:
  s_mul_i32 s46, s2, 12544
  s_add_u32 s46, s46, 12288
  v_lshl_add_u32 v235, v1, 2, s46
  buffer_load_dword v66, v235, s[28:31], 0 offen
  buffer_load_dword v74, v235, s[24:27], 0 offen
  v_lshrrev_b32 v235, 2, v1
  v_and_b32 v236, 3, v1
  v_lshlrev_b32 v238, 1, v236
  v_mov_b32 v230, 0
  v_cmp_eq_u32 vcc, v235, v238
  v_mov_b32 v226, 0x3f80
  v_mov_b32 v227, 0x3f800000
  v_cndmask_b32 v230, v230, v226, vcc
  v_add_u32 v238, 1, v238
  v_cmp_eq_u32 vcc, v235, v238
  s_nop 1
  v_cndmask_b32 v230, v230, v227, vcc
  v_cmp_eq_u32 vcc, 6, v235
  v_mov_b32 v228, 0
  s_nop 0
  v_cndmask_b32 v228, v228, v227, vcc
  v_cmp_eq_u32 vcc, 3, v236
  s_nop 1
  v_cndmask_b32 v230, v230, v228, vcc
  v_cmp_lt_u32 vcc, 31, v1
  v_lshlrev_b32 v235, 2, v1
  s_nop 0
  v_cndmask_b32 v230, v230, v200, vcc
  ds_write_b32 v235, v230
K_S_COMMON:
  s_mov_b32 s40, 0xffffffe0
  s_mov_b32 s41, 128
  s_mov_b32 s42, 703687442
  s_mov_b32 s43, 3125
  s_mov_b32 s60, 4294967294
  s_mov_b32 s61, 176
  s_mov_b32 s38, 0
  s_mov_b32 s39, 0
  v_mov_b32 v239, 1
  v_mov_b32 v240, 511
  v_mov_b32 v203, 0x40000000
  v_lshrrev_b32 v237, 5, v1
  v_bfe_u32 v235, v1, 2, 2
  v_lshl_add_u32 v235, v237, 3, v235
  v_lshlrev_b32 v241, 7, v235
  v_bfe_u32 v235, v1, 4, 1
  v_lshl_add_u32 v241, v235, 5, v241
  v_and_b32 v235, 3, v1
  v_lshl_add_u32 v241, v235, 3, v241
  v_mov_b32 v152, -1
  v_mov_b32 v153, -1
  v_mov_b32 v154, -1
  v_mov_b32 v155, -1
  v_lshlrev_b32 v235, 6, v0
  v_add_u32 v235, 127232, v235
  ds_write_b128 v235, v[152:155] offset:0
  ds_write_b128 v235, v[152:155] offset:16
  ds_write_b128 v235, v[152:155] offset:32
  ds_write_b128 v235, v[152:155] offset:48
  v_and_b32 v235, 0xff, v0
  v_lshlrev_b32 v235, 2, v235
  ds_write_b32 v235, v200 offset:256
  s_mov_b32 s20, s66
  s_and_b32 s21, s67, 0xffff
  s_mov_b32 s22, 75000
  s_mov_b32 s23, 0x20000
  s_mov_b32 s8, s68
  s_and_b32 s9, s69, 0xffff
  s_mov_b32 s10, 25600000
  s_mov_b32 s11, 0x20000
  s_mov_b32 s16, s76
  s_and_b32 s17, s77, 0xffff
  s_mov_b32 s18, 1675000
  s_mov_b32 s19, 0x20000
  s_add_u32 s4, s80, 8388608
  s_addc_u32 s5, s81, 0
  s_and_b32 s5, s5, 0xffff
  s_mov_b32 s6, 1600000
  s_mov_b32 s7, 0x20000
  s_waitcnt lgkmcnt(0)
  s_barrier
  s_mul_i32 s46, s2, 3136
  s_sub_u32 s44, 800000, s46
  s_min_u32 s44, s44, 3136
  s_mul_i32 s46, s32, 384
  v_lshl_add_u32 v235, v1, 1, s46
  s_cmp_eq_u32 s32, 4
  s_cbranch_scc1 K_S_WT4
  s_sub_u32 s46, s32, 5
  s_cmp_lt_u32 s46, 2
  s_cbranch_scc1 K_S_WT56
  s_cmp_eq_u32 s32, 0
  s_cbranch_scc1 K_S_WT0
  s_waitcnt vmcnt(0)
  s_branch K_S_WTD
K_S_WT0:
  s_waitcnt vmcnt(1)
  s_branch K_S_WTD
K_S_WT4:
  s_waitcnt vmcnt(2)
  s_branch K_S_WTD
K_S_WT56:
  s_waitcnt vmcnt(12)
K_S_WTD:
  s_cmp_lt_u32 s44, 3136
  s_cbranch_scc1 K_S_APPM
  s_cmp_eq_u32 s32, 7
  s_cbranch_scc1 K_S_APP7
  v_mul_hi_u32 v237, v60, s42
  v_add_u32 v236, 0, v235
  v_lshl_or_b32 v124, v68, 12, v236
  v_lshrrev_b32 v28, 1, v237
  v_mad_u32_u24 v238, v237, s43, v240
  v_and_b32 v28, 0x3fc, v28
  v_lshrrev_b32 v238, 9, v238
  ds_add_rtn_u32 v36, v28, v239 offset:256
  v_sub_u32 v238, v60, v238
  v_and_b32 v237, 7, v237
  v_lshl_or_b32 v238, v237, 3, v238
  v_lshl_or_b32 v124, v238, 26, v124
  v_mul_hi_u32 v237, v61, s42
  v_add_u32 v236, 1, v235
  v_lshl_or_b32 v125, v69, 12, v236
  v_lshrrev_b32 v29, 1, v237
  v_mad_u32_u24 v238, v237, s43, v240
  v_and_b32 v29, 0x3fc, v29
  v_lshrrev_b32 v238, 9, v238
  ds_add_rtn_u32 v37, v29, v239 offset:256
  v_sub_u32 v238, v61, v238
  v_and_b32 v237, 7, v237
  v_lshl_or_b32 v238, v237, 3, v238
  v_lshl_or_b32 v125, v238, 26, v125
  v_mul_hi_u32 v237, v62, s42
  v_add_u32 v236, 128, v235
  v_lshl_or_b32 v126, v70, 12, v236
  v_lshrrev_b32 v30, 1, v237
  v_mad_u32_u24 v238, v237, s43, v240
  v_and_b32 v30, 0x3fc, v30
  v_lshrrev_b32 v238, 9, v238
  ds_add_rtn_u32 v38, v30, v239 offset:256
  v_sub_u32 v238, v62, v238
  v_and_b32 v237, 7, v237
  v_lshl_or_b32 v238, v237, 3, v238
  v_lshl_or_b32 v126, v238, 26, v126
  v_mul_hi_u32 v237, v63, s42
  v_add_u32 v236, 129, v235
  v_lshl_or_b32 v127, v71, 12, v236
  v_lshrrev_b32 v31, 1, v237
  v_mad_u32_u24 v238, v237, s43, v240
  v_and_b32 v31, 0x3fc, v31
  v_lshrrev_b32 v238, 9, v238
  ds_add_rtn_u32 v39, v31, v239 offset:256
  v_sub_u32 v238, v63, v238
  v_and_b32 v237, 7, v237
  v_lshl_or_b32 v238, v237, 3, v238
  v_lshl_or_b32 v127, v238, 26, v127
  v_mul_hi_u32 v237, v64, s42
  v_add_u32 v236, 256, v235
  v_lshl_or_b32 v128, v72, 12, v236
  v_lshrrev_b32 v32, 1, v237
  v_mad_u32_u24 v238, v237, s43, v240
  v_and_b32 v32, 0x3fc, v32
  v_lshrrev_b32 v238, 9, v238
  ds_add_rtn_u32 v40, v32, v239 offset:256
  v_sub_u32 v238, v64, v238
  v_and_b32 v237, 7, v237
  v_lshl_or_b32 v238, v237, 3, v238
  v_lshl_or_b32 v128, v238, 26, v128
  v_mul_hi_u32 v237, v65, s42
  v_add_u32 v236, 257, v235
  v_lshl_or_b32 v129, v73, 12, v236
  v_lshrrev_b32 v33, 1, v237
  v_mad_u32_u24 v238, v237, s43, v240
  v_and_b32 v33, 0x3fc, v33
  v_lshrrev_b32 v238, 9, v238
  ds_add_rtn_u32 v41, v33, v239 offset:256
  v_sub_u32 v238, v65, v238
  v_and_b32 v237, 7, v237
  v_lshl_or_b32 v238, v237, 3, v238
  v_lshl_or_b32 v129, v238, 26, v129
  v_mov_b32 v238, 127232
  v_mov_b32 v230, 164
  s_waitcnt lgkmcnt(5)
  v_cmp_gt_u32 vcc, 32, v36
  v_lshlrev_b32 v236, 3, v36
  v_lshrrev_b32 v237, 2, v36
  v_and_b32 v236, 0x78, v236
  v_lshl_add_u32 v226, v28, 5, v238
  v_and_or_b32 v236, v237, 4, v236
  v_add_u32 v236, v236, v226
  v_cndmask_b32 v236, v230, v236, vcc
  ds_write_b32 v236, v124
  s_waitcnt lgkmcnt(5)
  v_cmp_gt_u32 vcc, 32, v37
  v_lshlrev_b32 v236, 3, v37
  v_lshrrev_b32 v237, 2, v37
  v_and_b32 v236, 0x78, v236
  v_lshl_add_u32 v226, v29, 5, v238
  v_and_or_b32 v236, v237, 4, v236
  v_add_u32 v236, v236, v226
  v_cndmask_b32 v236, v230, v236, vcc
  ds_write_b32 v236, v125
  s_waitcnt lgkmcnt(5)
  v_cmp_gt_u32 vcc, 32, v38
  v_lshlrev_b32 v236, 3, v38
  v_lshrrev_b32 v237, 2, v38
  v_and_b32 v236, 0x78, v236
  v_lshl_add_u32 v226, v30, 5, v238
  v_and_or_b32 v236, v237, 4, v236
  v_add_u32 v236, v236, v226
  v_cndmask_b32 v236, v230, v236, vcc
  ds_write_b32 v236, v126
  s_waitcnt lgkmcnt(5)
  v_cmp_gt_u32 vcc, 32, v39
  v_lshlrev_b32 v236, 3, v39
  v_lshrrev_b32 v237, 2, v39
  v_and_b32 v236, 0x78, v236
  v_lshl_add_u32 v226, v31, 5, v238
  v_and_or_b32 v236, v237, 4, v236
  v_add_u32 v236, v236, v226
  v_cndmask_b32 v236, v230, v236, vcc
  ds_write_b32 v236, v127
  s_waitcnt lgkmcnt(5)
  v_cmp_gt_u32 vcc, 32, v40
  v_lshlrev_b32 v236, 3, v40
  v_lshrrev_b32 v237, 2, v40
  v_and_b32 v236, 0x78, v236
  v_lshl_add_u32 v226, v32, 5, v238
  v_and_or_b32 v236, v237, 4, v236
  v_add_u32 v236, v236, v226
  v_cndmask_b32 v236, v230, v236, vcc
  ds_write_b32 v236, v128
  s_waitcnt lgkmcnt(5)
  v_cmp_gt_u32 vcc, 32, v41
  v_lshlrev_b32 v236, 3, v41
  v_lshrrev_b32 v237, 2, v41
  v_and_b32 v236, 0x78, v236
  v_lshl_add_u32 v226, v33, 5, v238
  v_and_or_b32 v236, v237, 4, v236
  v_add_u32 v236, v236, v226
  v_cndmask_b32 v236, v230, v236, vcc
  ds_write_b32 v236, v129
  s_branch K_S_APPD
K_S_APP7:
  v_mul_hi_u32 v237, v60, s42
  v_add_u32 v236, 0, v235
  v_lshl_or_b32 v124, v68, 12, v236
  v_lshrrev_b32 v28, 1, v237
  v_mad_u32_u24 v238, v237, s43, v240
  v_and_b32 v28, 0x3fc, v28
  v_lshrrev_b32 v238, 9, v238
  ds_add_rtn_u32 v36, v28, v239 offset:256
  v_sub_u32 v238, v60, v238
  v_and_b32 v237, 7, v237
  v_lshl_or_b32 v238, v237, 3, v238
  v_lshl_or_b32 v124, v238, 26, v124
  v_mul_hi_u32 v237, v61, s42
  v_add_u32 v236, 1, v235
  v_lshl_or_b32 v125, v69, 12, v236
  v_lshrrev_b32 v29, 1, v237
  v_mad_u32_u24 v238, v237, s43, v240
  v_and_b32 v29, 0x3fc, v29
  v_lshrrev_b32 v238, 9, v238
  ds_add_rtn_u32 v37, v29, v239 offset:256
  v_sub_u32 v238, v61, v238
  v_and_b32 v237, 7, v237
  v_lshl_or_b32 v238, v237, 3, v238
  v_lshl_or_b32 v125, v238, 26, v125
  v_mul_hi_u32 v237, v62, s42
  v_add_u32 v236, 128, v235
  v_lshl_or_b32 v126, v70, 12, v236
  v_lshrrev_b32 v30, 1, v237
  v_mad_u32_u24 v238, v237, s43, v240
  v_and_b32 v30, 0x3fc, v30
  v_lshrrev_b32 v238, 9, v238
  ds_add_rtn_u32 v38, v30, v239 offset:256
  v_sub_u32 v238, v62, v238
  v_and_b32 v237, 7, v237
  v_lshl_or_b32 v238, v237, 3, v238
  v_lshl_or_b32 v126, v238, 26, v126
  v_mul_hi_u32 v237, v63, s42
  v_add_u32 v236, 129, v235
  v_lshl_or_b32 v127, v71, 12, v236
  v_lshrrev_b32 v31, 1, v237
  v_mad_u32_u24 v238, v237, s43, v240
  v_and_b32 v31, 0x3fc, v31
  v_lshrrev_b32 v238, 9, v238
  ds_add_rtn_u32 v39, v31, v239 offset:256
  v_sub_u32 v238, v63, v238
  v_and_b32 v237, 7, v237
  v_lshl_or_b32 v238, v237, 3, v238
  v_lshl_or_b32 v127, v238, 26, v127
  v_mul_hi_u32 v237, v64, s42
  v_add_u32 v236, 256, v235
  v_lshl_or_b32 v128, v72, 12, v236
  v_lshrrev_b32 v32, 1, v237
  v_mad_u32_u24 v238, v237, s43, v240
  v_and_b32 v32, 0x3fc, v32
  v_lshrrev_b32 v238, 9, v238
  ds_add_rtn_u32 v40, v32, v239 offset:256
  v_sub_u32 v238, v64, v238
  v_and_b32 v237, 7, v237
  v_lshl_or_b32 v238, v237, 3, v238
  v_lshl_or_b32 v128, v238, 26, v128
  v_mul_hi_u32 v237, v65, s42
  v_add_u32 v236, 257, v235
  v_lshl_or_b32 v129, v73, 12, v236
  v_lshrrev_b32 v33, 1, v237
  v_mad_u32_u24 v238, v237, s43, v240
  v_and_b32 v33, 0x3fc, v33
  v_lshrrev_b32 v238, 9, v238
  ds_add_rtn_u32 v41, v33, v239 offset:256
  v_sub_u32 v238, v65, v238
  v_and_b32 v237, 7, v237
  v_lshl_or_b32 v238, v237, 3, v238
  v_lshl_or_b32 v129, v238, 26, v129
  v_mul_hi_u32 v237, v66, s42
  v_add_u32 v236, 3072, v1
  v_lshl_or_b32 v130, v74, 12, v236
  v_lshrrev_b32 v34, 1, v237
  v_mad_u32_u24 v238, v237, s43, v240
  v_and_b32 v34, 0x3fc, v34
  v_lshrrev_b32 v238, 9, v238
  ds_add_rtn_u32 v42, v34, v239 offset:256
  v_sub_u32 v238, v66, v238
  v_and_b32 v237, 7, v237
  v_lshl_or_b32 v238, v237, 3, v238
  v_lshl_or_b32 v130, v238, 26, v130
  v_mov_b32 v238, 127232
  v_mov_b32 v230, 164
  s_waitcnt lgkmcnt(6)
  v_cmp_gt_u32 vcc, 32, v36
  v_lshlrev_b32 v236, 3, v36
  v_lshrrev_b32 v237, 2, v36
  v_and_b32 v236, 0x78, v236
  v_lshl_add_u32 v226, v28, 5, v238
  v_and_or_b32 v236, v237, 4, v236
  v_add_u32 v236, v236, v226
  v_cndmask_b32 v236, v230, v236, vcc
  ds_write_b32 v236, v124
  s_waitcnt lgkmcnt(6)
  v_cmp_gt_u32 vcc, 32, v37
  v_lshlrev_b32 v236, 3, v37
  v_lshrrev_b32 v237, 2, v37
  v_and_b32 v236, 0x78, v236
  v_lshl_add_u32 v226, v29, 5, v238
  v_and_or_b32 v236, v237, 4, v236
  v_add_u32 v236, v236, v226
  v_cndmask_b32 v236, v230, v236, vcc
  ds_write_b32 v236, v125
  s_waitcnt lgkmcnt(6)
  v_cmp_gt_u32 vcc, 32, v38
  v_lshlrev_b32 v236, 3, v38
  v_lshrrev_b32 v237, 2, v38
  v_and_b32 v236, 0x78, v236
  v_lshl_add_u32 v226, v30, 5, v238
  v_and_or_b32 v236, v237, 4, v236
  v_add_u32 v236, v236, v226
  v_cndmask_b32 v236, v230, v236, vcc
  ds_write_b32 v236, v126
  s_waitcnt lgkmcnt(6)
  v_cmp_gt_u32 vcc, 32, v39
  v_lshlrev_b32 v236, 3, v39
  v_lshrrev_b32 v237, 2, v39
  v_and_b32 v236, 0x78, v236
  v_lshl_add_u32 v226, v31, 5, v238
  v_and_or_b32 v236, v237, 4, v236
  v_add_u32 v236, v236, v226
  v_cndmask_b32 v236, v230, v236, vcc
  ds_write_b32 v236, v127
  s_waitcnt lgkmcnt(6)
  v_cmp_gt_u32 vcc, 32, v40
  v_lshlrev_b32 v236, 3, v40
  v_lshrrev_b32 v237, 2, v40
  v_and_b32 v236, 0x78, v236
  v_lshl_add_u32 v226, v32, 5, v238
  v_and_or_b32 v236, v237, 4, v236
  v_add_u32 v236, v236, v226
  v_cndmask_b32 v236, v230, v236, vcc
  ds_write_b32 v236, v128
  s_waitcnt lgkmcnt(6)
  v_cmp_gt_u32 vcc, 32, v41
  v_lshlrev_b32 v236, 3, v41
  v_lshrrev_b32 v237, 2, v41
  v_and_b32 v236, 0x78, v236
  v_lshl_add_u32 v226, v33, 5, v238
  v_and_or_b32 v236, v237, 4, v236
  v_add_u32 v236, v236, v226
  v_cndmask_b32 v236, v230, v236, vcc
  ds_write_b32 v236, v129
  s_waitcnt lgkmcnt(6)
  v_cmp_gt_u32 vcc, 32, v42
  v_lshlrev_b32 v236, 3, v42
  v_lshrrev_b32 v237, 2, v42
  v_and_b32 v236, 0x78, v236
  v_lshl_add_u32 v226, v34, 5, v238
  v_and_or_b32 v236, v237, 4, v236
  v_add_u32 v236, v236, v226
  v_cndmask_b32 v236, v230, v236, vcc
  ds_write_b32 v236, v130
  s_branch K_S_APPD
K_S_APPM:
  s_cmp_eq_u32 s32, 7
  s_cbranch_scc1 K_S_APPM7
  v_add_u32 v236, 0, v235
  v_cmp_gt_u32 s[64:65], s44, v236
  v_add_u32 v236, 1, v235
  v_cmp_gt_u32 s[66:67], s44, v236
  v_add_u32 v236, 128, v235
  v_cmp_gt_u32 s[68:69], s44, v236
  v_add_u32 v236, 129, v235
  v_cmp_gt_u32 s[70:71], s44, v236
  v_add_u32 v236, 256, v235
  v_cmp_gt_u32 s[72:73], s44, v236
  v_add_u32 v236, 257, v235
  v_cmp_gt_u32 s[74:75], s44, v236
  v_mul_hi_u32 v237, v60, s42
  v_add_u32 v236, 0, v235
  v_lshl_or_b32 v124, v68, 12, v236
  v_lshrrev_b32 v28, 1, v237
  v_mad_u32_u24 v238, v237, s43, v240
  v_and_b32 v28, 0x3fc, v28
  v_lshrrev_b32 v238, 9, v238
  s_mov_b64 exec, s[64:65]
  ds_add_rtn_u32 v36, v28, v239 offset:256
  s_mov_b64 exec, -1
  v_sub_u32 v238, v60, v238
  v_and_b32 v237, 7, v237
  v_lshl_or_b32 v238, v237, 3, v238
  v_lshl_or_b32 v124, v238, 26, v124
  v_mul_hi_u32 v237, v61, s42
  v_add_u32 v236, 1, v235
  v_lshl_or_b32 v125, v69, 12, v236
  v_lshrrev_b32 v29, 1, v237
  v_mad_u32_u24 v238, v237, s43, v240
  v_and_b32 v29, 0x3fc, v29
  v_lshrrev_b32 v238, 9, v238
  s_mov_b64 exec, s[66:67]
  ds_add_rtn_u32 v37, v29, v239 offset:256
  s_mov_b64 exec, -1
  v_sub_u32 v238, v61, v238
  v_and_b32 v237, 7, v237
  v_lshl_or_b32 v238, v237, 3, v238
  v_lshl_or_b32 v125, v238, 26, v125
  v_mul_hi_u32 v237, v62, s42
  v_add_u32 v236, 128, v235
  v_lshl_or_b32 v126, v70, 12, v236
  v_lshrrev_b32 v30, 1, v237
  v_mad_u32_u24 v238, v237, s43, v240
  v_and_b32 v30, 0x3fc, v30
  v_lshrrev_b32 v238, 9, v238
  s_mov_b64 exec, s[68:69]
  ds_add_rtn_u32 v38, v30, v239 offset:256
  s_mov_b64 exec, -1
  v_sub_u32 v238, v62, v238
  v_and_b32 v237, 7, v237
  v_lshl_or_b32 v238, v237, 3, v238
  v_lshl_or_b32 v126, v238, 26, v126
  v_mul_hi_u32 v237, v63, s42
  v_add_u32 v236, 129, v235
  v_lshl_or_b32 v127, v71, 12, v236
  v_lshrrev_b32 v31, 1, v237
  v_mad_u32_u24 v238, v237, s43, v240
  v_and_b32 v31, 0x3fc, v31
  v_lshrrev_b32 v238, 9, v238
  s_mov_b64 exec, s[70:71]
  ds_add_rtn_u32 v39, v31, v239 offset:256
  s_mov_b64 exec, -1
  v_sub_u32 v238, v63, v238
  v_and_b32 v237, 7, v237
  v_lshl_or_b32 v238, v237, 3, v238
  v_lshl_or_b32 v127, v238, 26, v127
  v_mul_hi_u32 v237, v64, s42
  v_add_u32 v236, 256, v235
  v_lshl_or_b32 v128, v72, 12, v236
  v_lshrrev_b32 v32, 1, v237
  v_mad_u32_u24 v238, v237, s43, v240
  v_and_b32 v32, 0x3fc, v32
  v_lshrrev_b32 v238, 9, v238
  s_mov_b64 exec, s[72:73]
  ds_add_rtn_u32 v40, v32, v239 offset:256
  s_mov_b64 exec, -1
  v_sub_u32 v238, v64, v238
  v_and_b32 v237, 7, v237
  v_lshl_or_b32 v238, v237, 3, v238
  v_lshl_or_b32 v128, v238, 26, v128
  v_mul_hi_u32 v237, v65, s42
  v_add_u32 v236, 257, v235
  v_lshl_or_b32 v129, v73, 12, v236
  v_lshrrev_b32 v33, 1, v237
  v_mad_u32_u24 v238, v237, s43, v240
  v_and_b32 v33, 0x3fc, v33
  v_lshrrev_b32 v238, 9, v238
  s_mov_b64 exec, s[74:75]
  ds_add_rtn_u32 v41, v33, v239 offset:256
  s_mov_b64 exec, -1
  v_sub_u32 v238, v65, v238
  v_and_b32 v237, 7, v237
  v_lshl_or_b32 v238, v237, 3, v238
  v_lshl_or_b32 v129, v238, 26, v129
  v_mov_b32 v238, 127232
  v_mov_b32 v230, 164
  s_waitcnt lgkmcnt(0)
  v_cmp_gt_u32 vcc, 32, v36
  v_lshlrev_b32 v236, 3, v36
  v_lshrrev_b32 v237, 2, v36
  v_and_b32 v236, 0x78, v236
  v_lshl_add_u32 v226, v28, 5, v238
  v_and_or_b32 v236, v237, 4, v236
  v_add_u32 v236, v236, v226
  v_cndmask_b32 v236, v230, v236, vcc
  s_mov_b64 exec, s[64:65]
  ds_write_b32 v236, v124
  s_mov_b64 exec, -1
  v_cmp_gt_u32 vcc, 32, v37
  v_lshlrev_b32 v236, 3, v37
  v_lshrrev_b32 v237, 2, v37
  v_and_b32 v236, 0x78, v236
  v_lshl_add_u32 v226, v29, 5, v238
  v_and_or_b32 v236, v237, 4, v236
  v_add_u32 v236, v236, v226
  v_cndmask_b32 v236, v230, v236, vcc
  s_mov_b64 exec, s[66:67]
  ds_write_b32 v236, v125
  s_mov_b64 exec, -1
  v_cmp_gt_u32 vcc, 32, v38
  v_lshlrev_b32 v236, 3, v38
  v_lshrrev_b32 v237, 2, v38
  v_and_b32 v236, 0x78, v236
  v_lshl_add_u32 v226, v30, 5, v238
  v_and_or_b32 v236, v237, 4, v236
  v_add_u32 v236, v236, v226
  v_cndmask_b32 v236, v230, v236, vcc
  s_mov_b64 exec, s[68:69]
  ds_write_b32 v236, v126
  s_mov_b64 exec, -1
  v_cmp_gt_u32 vcc, 32, v39
  v_lshlrev_b32 v236, 3, v39
  v_lshrrev_b32 v237, 2, v39
  v_and_b32 v236, 0x78, v236
  v_lshl_add_u32 v226, v31, 5, v238
  v_and_or_b32 v236, v237, 4, v236
  v_add_u32 v236, v236, v226
  v_cndmask_b32 v236, v230, v236, vcc
  s_mov_b64 exec, s[70:71]
  ds_write_b32 v236, v127
  s_mov_b64 exec, -1
  v_cmp_gt_u32 vcc, 32, v40
  v_lshlrev_b32 v236, 3, v40
  v_lshrrev_b32 v237, 2, v40
  v_and_b32 v236, 0x78, v236
  v_lshl_add_u32 v226, v32, 5, v238
  v_and_or_b32 v236, v237, 4, v236
  v_add_u32 v236, v236, v226
  v_cndmask_b32 v236, v230, v236, vcc
  s_mov_b64 exec, s[72:73]
  ds_write_b32 v236, v128
  s_mov_b64 exec, -1
  v_cmp_gt_u32 vcc, 32, v41
  v_lshlrev_b32 v236, 3, v41
  v_lshrrev_b32 v237, 2, v41
  v_and_b32 v236, 0x78, v236
  v_lshl_add_u32 v226, v33, 5, v238
  v_and_or_b32 v236, v237, 4, v236
  v_add_u32 v236, v236, v226
  v_cndmask_b32 v236, v230, v236, vcc
  s_mov_b64 exec, s[74:75]
  ds_write_b32 v236, v129
  s_mov_b64 exec, -1
  s_branch K_S_APPD
K_S_APPM7:
  v_add_u32 v236, 0, v235
  v_cmp_gt_u32 s[64:65], s44, v236
  v_add_u32 v236, 1, v235
  v_cmp_gt_u32 s[66:67], s44, v236
  v_add_u32 v236, 128, v235
  v_cmp_gt_u32 s[68:69], s44, v236
  v_add_u32 v236, 129, v235
  v_cmp_gt_u32 s[70:71], s44, v236
  v_add_u32 v236, 256, v235
  v_cmp_gt_u32 s[72:73], s44, v236
  v_add_u32 v236, 257, v235
  v_cmp_gt_u32 s[74:75], s44, v236
  v_add_u32 v236, 3072, v1
  v_cmp_gt_u32 s[76:77], s44, v236
  v_mul_hi_u32 v237, v60, s42
  v_add_u32 v236, 0, v235
  v_lshl_or_b32 v124, v68, 12, v236
  v_lshrrev_b32 v28, 1, v237
  v_mad_u32_u24 v238, v237, s43, v240
  v_and_b32 v28, 0x3fc, v28
  v_lshrrev_b32 v238, 9, v238
  s_mov_b64 exec, s[64:65]
  ds_add_rtn_u32 v36, v28, v239 offset:256
  s_mov_b64 exec, -1
  v_sub_u32 v238, v60, v238
  v_and_b32 v237, 7, v237
  v_lshl_or_b32 v238, v237, 3, v238
  v_lshl_or_b32 v124, v238, 26, v124
  v_mul_hi_u32 v237, v61, s42
  v_add_u32 v236, 1, v235
  v_lshl_or_b32 v125, v69, 12, v236
  v_lshrrev_b32 v29, 1, v237
  v_mad_u32_u24 v238, v237, s43, v240
  v_and_b32 v29, 0x3fc, v29
  v_lshrrev_b32 v238, 9, v238
  s_mov_b64 exec, s[66:67]
  ds_add_rtn_u32 v37, v29, v239 offset:256
  s_mov_b64 exec, -1
  v_sub_u32 v238, v61, v238
  v_and_b32 v237, 7, v237
  v_lshl_or_b32 v238, v237, 3, v238
  v_lshl_or_b32 v125, v238, 26, v125
  v_mul_hi_u32 v237, v62, s42
  v_add_u32 v236, 128, v235
  v_lshl_or_b32 v126, v70, 12, v236
  v_lshrrev_b32 v30, 1, v237
  v_mad_u32_u24 v238, v237, s43, v240
  v_and_b32 v30, 0x3fc, v30
  v_lshrrev_b32 v238, 9, v238
  s_mov_b64 exec, s[68:69]
  ds_add_rtn_u32 v38, v30, v239 offset:256
  s_mov_b64 exec, -1
  v_sub_u32 v238, v62, v238
  v_and_b32 v237, 7, v237
  v_lshl_or_b32 v238, v237, 3, v238
  v_lshl_or_b32 v126, v238, 26, v126
  v_mul_hi_u32 v237, v63, s42
  v_add_u32 v236, 129, v235
  v_lshl_or_b32 v127, v71, 12, v236
  v_lshrrev_b32 v31, 1, v237
  v_mad_u32_u24 v238, v237, s43, v240
  v_and_b32 v31, 0x3fc, v31
  v_lshrrev_b32 v238, 9, v238
  s_mov_b64 exec, s[70:71]
  ds_add_rtn_u32 v39, v31, v239 offset:256
  s_mov_b64 exec, -1
  v_sub_u32 v238, v63, v238
  v_and_b32 v237, 7, v237
  v_lshl_or_b32 v238, v237, 3, v238
  v_lshl_or_b32 v127, v238, 26, v127
  v_mul_hi_u32 v237, v64, s42
  v_add_u32 v236, 256, v235
  v_lshl_or_b32 v128, v72, 12, v236
  v_lshrrev_b32 v32, 1, v237
  v_mad_u32_u24 v238, v237, s43, v240
  v_and_b32 v32, 0x3fc, v32
  v_lshrrev_b32 v238, 9, v238
  s_mov_b64 exec, s[72:73]
  ds_add_rtn_u32 v40, v32, v239 offset:256
  s_mov_b64 exec, -1
  v_sub_u32 v238, v64, v238
  v_and_b32 v237, 7, v237
  v_lshl_or_b32 v238, v237, 3, v238
  v_lshl_or_b32 v128, v238, 26, v128
  v_mul_hi_u32 v237, v65, s42
  v_add_u32 v236, 257, v235
  v_lshl_or_b32 v129, v73, 12, v236
  v_lshrrev_b32 v33, 1, v237
  v_mad_u32_u24 v238, v237, s43, v240
  v_and_b32 v33, 0x3fc, v33
  v_lshrrev_b32 v238, 9, v238
  s_mov_b64 exec, s[74:75]
  ds_add_rtn_u32 v41, v33, v239 offset:256
  s_mov_b64 exec, -1
  v_sub_u32 v238, v65, v238
  v_and_b32 v237, 7, v237
  v_lshl_or_b32 v238, v237, 3, v238
  v_lshl_or_b32 v129, v238, 26, v129
  v_mul_hi_u32 v237, v66, s42
  v_add_u32 v236, 3072, v1
  v_lshl_or_b32 v130, v74, 12, v236
  v_lshrrev_b32 v34, 1, v237
  v_mad_u32_u24 v238, v237, s43, v240
  v_and_b32 v34, 0x3fc, v34
  v_lshrrev_b32 v238, 9, v238
  s_mov_b64 exec, s[76:77]
  ds_add_rtn_u32 v42, v34, v239 offset:256
  s_mov_b64 exec, -1
  v_sub_u32 v238, v66, v238
  v_and_b32 v237, 7, v237
  v_lshl_or_b32 v238, v237, 3, v238
  v_lshl_or_b32 v130, v238, 26, v130
  v_mov_b32 v238, 127232
  v_mov_b32 v230, 164
  s_waitcnt lgkmcnt(0)
  v_cmp_gt_u32 vcc, 32, v36
  v_lshlrev_b32 v236, 3, v36
  v_lshrrev_b32 v237, 2, v36
  v_and_b32 v236, 0x78, v236
  v_lshl_add_u32 v226, v28, 5, v238
  v_and_or_b32 v236, v237, 4, v236
  v_add_u32 v236, v236, v226
  v_cndmask_b32 v236, v230, v236, vcc
  s_mov_b64 exec, s[64:65]
  ds_write_b32 v236, v124
  s_mov_b64 exec, -1
  v_cmp_gt_u32 vcc, 32, v37
  v_lshlrev_b32 v236, 3, v37
  v_lshrrev_b32 v237, 2, v37
  v_and_b32 v236, 0x78, v236
  v_lshl_add_u32 v226, v29, 5, v238
  v_and_or_b32 v236, v237, 4, v236
  v_add_u32 v236, v236, v226
  v_cndmask_b32 v236, v230, v236, vcc
  s_mov_b64 exec, s[66:67]
  ds_write_b32 v236, v125
  s_mov_b64 exec, -1
  v_cmp_gt_u32 vcc, 32, v38
  v_lshlrev_b32 v236, 3, v38
  v_lshrrev_b32 v237, 2, v38
  v_and_b32 v236, 0x78, v236
  v_lshl_add_u32 v226, v30, 5, v238
  v_and_or_b32 v236, v237, 4, v236
  v_add_u32 v236, v236, v226
  v_cndmask_b32 v236, v230, v236, vcc
  s_mov_b64 exec, s[68:69]
  ds_write_b32 v236, v126
  s_mov_b64 exec, -1
  v_cmp_gt_u32 vcc, 32, v39
  v_lshlrev_b32 v236, 3, v39
  v_lshrrev_b32 v237, 2, v39
  v_and_b32 v236, 0x78, v236
  v_lshl_add_u32 v226, v31, 5, v238
  v_and_or_b32 v236, v237, 4, v236
  v_add_u32 v236, v236, v226
  v_cndmask_b32 v236, v230, v236, vcc
  s_mov_b64 exec, s[70:71]
  ds_write_b32 v236, v127
  s_mov_b64 exec, -1
  v_cmp_gt_u32 vcc, 32, v40
  v_lshlrev_b32 v236, 3, v40
  v_lshrrev_b32 v237, 2, v40
  v_and_b32 v236, 0x78, v236
  v_lshl_add_u32 v226, v32, 5, v238
  v_and_or_b32 v236, v237, 4, v236
  v_add_u32 v236, v236, v226
  v_cndmask_b32 v236, v230, v236, vcc
  s_mov_b64 exec, s[72:73]
  ds_write_b32 v236, v128
  s_mov_b64 exec, -1
  v_cmp_gt_u32 vcc, 32, v41
  v_lshlrev_b32 v236, 3, v41
  v_lshrrev_b32 v237, 2, v41
  v_and_b32 v236, 0x78, v236
  v_lshl_add_u32 v226, v33, 5, v238
  v_and_or_b32 v236, v237, 4, v236
  v_add_u32 v236, v236, v226
  v_cndmask_b32 v236, v230, v236, vcc
  s_mov_b64 exec, s[74:75]
  ds_write_b32 v236, v129
  s_mov_b64 exec, -1
  v_cmp_gt_u32 vcc, 32, v42
  v_lshlrev_b32 v236, 3, v42
  v_lshrrev_b32 v237, 2, v42
  v_and_b32 v236, 0x78, v236
  v_lshl_add_u32 v226, v34, 5, v238
  v_and_or_b32 v236, v237, 4, v236
  v_add_u32 v236, v236, v226
  v_cndmask_b32 v236, v230, v236, vcc
  s_mov_b64 exec, s[76:77]
  ds_write_b32 v236, v130
  s_mov_b64 exec, -1
K_S_APPD:
  s_or_b32 s46, s2, s32
  s_cmp_lg_u32 s46, 0
  s_cbranch_scc1 K_S_NOTAG
  s_waitcnt vmcnt(0)
  s_mov_b32 s46, 0x9e3779b1
  v_mul_lo_u32 v236, v202, s46
  v_add_u32 v236, 0x7f4a7c15, v236
  v_max_u32 v236, 1, v236
  buffer_store_dword v236, v200, s[92:95], 0 offen sc1
  buffer_store_dword v236, v200, s[92:95], 0 offen offset:128 sc1
K_S_NOTAG:
  v_bfe_u32 v235, v1, 3, 1
  v_and_b32 v237, 3, v1
  v_lshl_add_u32 v235, v235, 2, v237
  s_sub_u32 s46, s34, 1
  v_min_u32 v235, s46, v235
  v_add_u32 v235, s33, v235
  v_lshl_add_u32 v235, v235, 7, v198
  buffer_load_dwordx4 v[108:111], v235, s[48:51], 0 offen offset:0
  buffer_load_dwordx4 v[112:115], v235, s[48:51], 0 offen offset:32
  buffer_load_dwordx4 v[116:119], v235, s[48:51], 0 offen offset:64
  buffer_load_dwordx4 v[120:123], v235, s[48:51], 0 offen offset:96
  s_lshl_b32 s46, 1, s32
  s_and_b32 s46, s46, 0x90
  s_cbranch_scc0 K_S_NORAW
  s_load_dwordx2 s[100:101], s[0:1], 40
  s_cmp_eq_u32 s32, 7
  s_cselect_b32 s63, 10240, 0
  s_waitcnt lgkmcnt(0)
  s_mov_b32 s88, s100
  s_and_b32 s89, s101, 0xffff
  s_mov_b32 s90, 18560
  s_mov_b32 s91, 0x20000
  s_add_u32 s47, s63, 0
  s_add_u32 s46, s47, 77056
  s_mov_b32 m0, s46
  s_nop 0
  buffer_load_dwordx4 v242, s[88:91], s47 offen lds
  s_add_u32 s47, s63, 1024
  s_add_u32 s46, s47, 77056
  s_mov_b32 m0, s46
  s_nop 0
  buffer_load_dwordx4 v242, s[88:91], s47 offen lds
  s_add_u32 s47, s63, 2048
  s_add_u32 s46, s47, 77056
  s_mov_b32 m0, s46
  s_nop 0
  buffer_load_dwordx4 v242, s[88:91], s47 offen lds
  s_add_u32 s47, s63, 3072
  s_add_u32 s46, s47, 77056
  s_mov_b32 m0, s46
  s_nop 0
  buffer_load_dwordx4 v242, s[88:91], s47 offen lds
  s_add_u32 s47, s63, 4096
  s_add_u32 s46, s47, 77056
  s_mov_b32 m0, s46
  s_nop 0
  buffer_load_dwordx4 v242, s[88:91], s47 offen lds
  s_add_u32 s47, s63, 5120
  s_add_u32 s46, s47, 77056
  s_mov_b32 m0, s46
  s_nop 0
  buffer_load_dwordx4 v242, s[88:91], s47 offen lds
  s_add_u32 s47, s63, 6144
  s_add_u32 s46, s47, 77056
  s_mov_b32 m0, s46
  s_nop 0
  buffer_load_dwordx4 v242, s[88:91], s47 offen lds
  s_add_u32 s47, s63, 7168
  s_add_u32 s46, s47, 77056
  s_mov_b32 m0, s46
  s_nop 0
  buffer_load_dwordx4 v242, s[88:91], s47 offen lds
  s_add_u32 s47, s63, 8192
  s_add_u32 s46, s47, 77056
  s_mov_b32 m0, s46
  s_nop 0
  buffer_load_dwordx4 v242, s[88:91], s47 offen lds
  s_add_u32 s47, s63, 9216
  s_min_u32 s47, s47, 18432
  s_add_u32 s46, s47, 77056
  s_mov_b32 m0, s46
  s_nop 0
  buffer_load_dwordx4 v242, s[88:91], s47 offen lds
K_S_NORAW:
  s_waitcnt lgkmcnt(0)
  s_barrier
  s_cmp_gt_u32 s32, 3
  s_cbranch_scc1 K_S_NOCOPY
  v_lshlrev_b32 v235, 4, v0
  v_add_u32 v235, 127232, v235
  v_lshrrev_b32 v236, 3, v0
  v_lshlrev_b32 v237, 2, v236
  ds_read_b128 v[60:63], v235 offset:0
  ds_read_b32 v28, v237 offset:256
  ds_read_b128 v[64:67], v235 offset:4096
  ds_read_b32 v29, v237 offset:384
  ds_read_b128 v[68:71], v235 offset:8192
  ds_read_b32 v30, v237 offset:512
  ds_read_b128 v[72:75], v235 offset:12288
  ds_read_b32 v31, v237 offset:640
  v_and_b32 v238, 7, v0
  v_cmp_eq_u32 vcc, 0, v238
  v_mov_b32 v230, -1
  v_lshlrev_b32 v236, 15, v236
  v_cndmask_b32_e64 v227, -1, -2, vcc
  v_lshl_add_u32 v236, v238, 4, v236
  s_lshl_b32 s46, s2, 7
  ds_read_b128 v[76:79], v235 offset:16384
  ds_read_b32 v32, v237 offset:768
  s_waitcnt lgkmcnt(8)
  v_cmp_lt_u32 vcc, 32, v28
  s_add_u32 s47, s46, 0
  s_nop 0
  v_cndmask_b32 v60, v60, v227, vcc
  v_cndmask_b32 v61, v61, v230, vcc
  v_cndmask_b32 v62, v62, v230, vcc
  v_cndmask_b32 v63, v63, v230, vcc
  buffer_store_dwordx4 v[60:63], v236, s[12:15], s47 offen sc1
  ds_read_b128 v[80:83], v235 offset:20480
  ds_read_b32 v33, v237 offset:896
  s_waitcnt lgkmcnt(8)
  v_cmp_lt_u32 vcc, 32, v29
  s_add_u32 s47, s46, 1048576
  s_nop 0
  v_cndmask_b32 v64, v64, v227, vcc
  v_cndmask_b32 v65, v65, v230, vcc
  v_cndmask_b32 v66, v66, v230, vcc
  v_cndmask_b32 v67, v67, v230, vcc
  buffer_store_dwordx4 v[64:67], v236, s[12:15], s47 offen sc1
  ds_read_b128 v[84:87], v235 offset:24576
  ds_read_b32 v34, v237 offset:1024
  s_waitcnt lgkmcnt(8)
  v_cmp_lt_u32 vcc, 32, v30
  s_add_u32 s47, s46, 2097152
  s_nop 0
  v_cndmask_b32 v68, v68, v227, vcc
  v_cndmask_b32 v69, v69, v230, vcc
  v_cndmask_b32 v70, v70, v230, vcc
  v_cndmask_b32 v71, v71, v230, vcc
  buffer_store_dwordx4 v[68:71], v236, s[12:15], s47 offen sc1
  ds_read_b128 v[88:91], v235 offset:28672
  ds_read_b32 v35, v237 offset:1152
  s_waitcnt lgkmcnt(8)
  v_cmp_lt_u32 vcc, 32, v31
  s_add_u32 s47, s46, 3145728
  s_nop 0
  v_cndmask_b32 v72, v72, v227, vcc
  v_cndmask_b32 v73, v73, v230, vcc
  v_cndmask_b32 v74, v74, v230, vcc
  v_cndmask_b32 v75, v75, v230, vcc
  buffer_store_dwordx4 v[72:75], v236, s[12:15], s47 offen sc1
  s_waitcnt lgkmcnt(6)
  v_cmp_lt_u32 vcc, 32, v32
  s_add_u32 s47, s46, 4194304
  s_nop 0
  v_cndmask_b32 v76, v76, v227, vcc
  v_cndmask_b32 v77, v77, v230, vcc
  v_cndmask_b32 v78, v78, v230, vcc
  v_cndmask_b32 v79, v79, v230, vcc
  buffer_store_dwordx4 v[76:79], v236, s[12:15], s47 offen sc1
  s_waitcnt lgkmcnt(4)
  v_cmp_lt_u32 vcc, 32, v33
  s_add_u32 s47, s46, 5242880
  s_nop 0
  v_cndmask_b32 v80, v80, v227, vcc
  v_cndmask_b32 v81, v81, v230, vcc
  v_cndmask_b32 v82, v82, v230, vcc
  v_cndmask_b32 v83, v83, v230, vcc
  buffer_store_dwordx4 v[80:83], v236, s[12:15], s47 offen sc1
  s_waitcnt lgkmcnt(2)
  v_cmp_lt_u32 vcc, 32, v34
  s_add_u32 s47, s46, 6291456
  s_nop 0
  v_cndmask_b32 v84, v84, v227, vcc
  v_cndmask_b32 v85, v85, v230, vcc
  v_cndmask_b32 v86, v86, v230, vcc
  v_cndmask_b32 v87, v87, v230, vcc
  buffer_store_dwordx4 v[84:87], v236, s[12:15], s47 offen sc1
  s_waitcnt lgkmcnt(0)
  v_cmp_lt_u32 vcc, 32, v35
  s_add_u32 s47, s46, 7340032
  s_nop 0
  v_cndmask_b32 v88, v88, v227, vcc
  v_cndmask_b32 v89, v89, v230, vcc
  v_cndmask_b32 v90, v90, v230, vcc
  v_cndmask_b32 v91, v91, v230, vcc
  buffer_store_dwordx4 v[88:91], v236, s[12:15], s47 offen sc1
  s_and_b32 s36, s2, 1
  s_lshl_b32 s36, s36, 7
  s_cmp_lg_u32 s32, 0
  s_cbranch_scc1 K_S_NOTAG1
  buffer_load_dword v231, v200, s[92:95], s36 offen sc1
K_S_NOTAG1:
  s_branch K_S_STATIC
K_S_NOCOPY:
  s_sub_u32 s46, s32, 5
  s_cmp_lt_u32 s46, 2
  s_cbranch_scc0 K_S_POS
  v_add_u32 v235, s58, v241
  s_waitcnt vmcnt(4)
  ds_read_b64_tr_b16 v[60:61], v235 offset:0
  ds_read_b64_tr_b16 v[62:63], v235 offset:512
  ds_read_b64_tr_b16 v[64:65], v235 offset:64
  ds_read_b64_tr_b16 v[66:67], v235 offset:576
  ds_read_b64_tr_b16 v[68:69], v235 offset:2048
  ds_read_b64_tr_b16 v[70:71], v235 offset:2560
  ds_read_b64_tr_b16 v[72:73], v235 offset:2112
  ds_read_b64_tr_b16 v[74:75], v235 offset:2624
  ds_read_b64_tr_b16 v[76:77], v235 offset:4096
  ds_read_b64_tr_b16 v[78:79], v235 offset:4608
  ds_read_b64_tr_b16 v[80:81], v235 offset:4160
  ds_read_b64_tr_b16 v[82:83], v235 offset:4672
  ds_read_b64_tr_b16 v[84:85], v235 offset:6144
  ds_read_b64_tr_b16 v[86:87], v235 offset:6656
  ds_read_b64_tr_b16 v[88:89], v235 offset:6208
  ds_read_b64_tr_b16 v[90:91], v235 offset:6720
  s_waitcnt lgkmcnt(0)
  v_mfma_f32_32x32x16_bf16 v[28:43], v[60:63], v[92:95], 0
  v_mfma_f32_32x32x16_bf16 v[28:43], v[68:71], v[96:99], v[28:43]
  v_mfma_f32_32x32x16_bf16 v[28:43], v[76:79], v[100:103], v[28:43]
  v_mfma_f32_32x32x16_bf16 v[28:43], v[84:87], v[104:107], v[28:43]
  v_mfma_f32_32x32x16_bf16 v[44:59], v[64:67], v[92:95], 0
  v_mfma_f32_32x32x16_bf16 v[44:59], v[72:75], v[96:99], v[44:59]
  v_mfma_f32_32x32x16_bf16 v[44:59], v[80:83], v[100:103], v[44:59]
  v_mfma_f32_32x32x16_bf16 v[44:59], v[88:91], v[104:107], v[44:59]
  s_mul_i32 s46, s57, 4608
  s_add_u32 s46, s46, 96512
  v_and_b32 v236, 31, v1
  v_mul_u32_u24 v236, 144, v236
  v_lshrrev_b32 v237, 5, v1
  v_lshl_add_u32 v236, v237, 3, v236
  v_add_u32 v236, s46, v236
  v_lshrrev_b32 v237, 3, v1
  v_mul_u32_u24 v238, 144, v237
  v_and_b32 v230, 7, v1
  v_lshl_add_u32 v238, v230, 4, v238
  v_add_u32 v238, s46, v238
  s_mov_b32 s47, 3216550459
  s_nop 3
  v_mul_f32 v28, s47, v28
  v_mul_f32 v29, s47, v29
  v_mul_f32 v30, s47, v30
  v_mul_f32 v31, s47, v31
  v_mul_f32 v32, s47, v32
  v_mul_f32 v33, s47, v33
  v_mul_f32 v34, s47, v34
  v_mul_f32 v35, s47, v35
  v_mul_f32 v36, s47, v36
  v_mul_f32 v37, s47, v37
  v_mul_f32 v38, s47, v38
  v_mul_f32 v39, s47, v39
  v_mul_f32 v40, s47, v40
  v_mul_f32 v41, s47, v41
  v_mul_f32 v42, s47, v42
  v_mul_f32 v43, s47, v43
  v_cvt_pk_bf16_f32 v220, v28, v29
  v_cvt_pk_bf16_f32 v221, v30, v31
  ds_write_b64 v236, v[220:221] offset:0
  s_nop 0
  v_cvt_pk_bf16_f32 v220, v32, v33
  v_cvt_pk_bf16_f32 v221, v34, v35
  ds_write_b64 v236, v[220:221] offset:16
  s_nop 0
  v_cvt_pk_bf16_f32 v220, v36, v37
  v_cvt_pk_bf16_f32 v221, v38, v39
  ds_write_b64 v236, v[220:221] offset:32
  s_nop 0
  v_cvt_pk_bf16_f32 v220, v40, v41
  v_cvt_pk_bf16_f32 v221, v42, v43
  ds_write_b64 v236, v[220:221] offset:48
  s_nop 0
  v_mul_f32 v44, s47, v44
  v_mul_f32 v45, s47, v45
  v_mul_f32 v46, s47, v46
  v_mul_f32 v47, s47, v47
  v_mul_f32 v48, s47, v48
  v_mul_f32 v49, s47, v49
  v_mul_f32 v50, s47, v50
  v_mul_f32 v51, s47, v51
  v_mul_f32 v52, s47, v52
  v_mul_f32 v53, s47, v53
  v_mul_f32 v54, s47, v54
  v_mul_f32 v55, s47, v55
  v_mul_f32 v56, s47, v56
  v_mul_f32 v57, s47, v57
  v_mul_f32 v58, s47, v58
  v_mul_f32 v59, s47, v59
  v_cvt_pk_bf16_f32 v220, v44, v45
  v_cvt_pk_bf16_f32 v221, v46, v47
  ds_write_b64 v236, v[220:221] offset:64
  s_nop 0
  v_cvt_pk_bf16_f32 v220, v48, v49
  v_cvt_pk_bf16_f32 v221, v50, v51
  ds_write_b64 v236, v[220:221] offset:80
  s_nop 0
  v_cvt_pk_bf16_f32 v220, v52, v53
  v_cvt_pk_bf16_f32 v221, v54, v55
  ds_write_b64 v236, v[220:221] offset:96
  s_nop 0
  v_cvt_pk_bf16_f32 v220, v56, v57
  v_cvt_pk_bf16_f32 v221, v58, v59
  ds_write_b64 v236, v[220:221] offset:112
  s_nop 0
  ds_read_b128 v[60:63], v238 offset:0
  ds_read_b128 v[64:67], v238 offset:1152
  ds_read_b128 v[68:71], v238 offset:2304
  ds_read_b128 v[72:75], v238 offset:3456
  s_lshl_b32 s47, s57, 5
  v_add_u32 v237, s47, v237
  s_mul_i32 s46, s2, 49
  v_add_u32 v235, s46, v237
  v_lshlrev_b32 v236, 7, v235
  v_lshl_add_u32 v236, v230, 4, v236
  v_mov_b32 v230, 0x40000000
  s_waitcnt lgkmcnt(0)
  v_add_u32 v238, 0, v237
  v_cmp_gt_u32 vcc, 49, v238
  v_add_u32 v226, 0, v236
  s_nop 0
  v_cndmask_b32 v226, v230, v226, vcc
  buffer_store_dwordx4 v[60:63], v226, s[4:7], 0 offen sc1
  v_add_u32 v238, 8, v237
  v_cmp_gt_u32 vcc, 49, v238
  v_add_u32 v226, 1024, v236
  s_nop 0
  v_cndmask_b32 v226, v230, v226, vcc
  buffer_store_dwordx4 v[64:67], v226, s[4:7], 0 offen sc1
  v_add_u32 v238, 16, v237
  v_cmp_gt_u32 vcc, 49, v238
  v_add_u32 v226, 2048, v236
  s_nop 0
  v_cndmask_b32 v226, v230, v226, vcc
  buffer_store_dwordx4 v[68:71], v226, s[4:7], 0 offen sc1
  v_add_u32 v238, 24, v237
  v_cmp_gt_u32 vcc, 49, v238
  v_add_u32 v226, 3072, v236
  s_nop 0
  v_cndmask_b32 v226, v230, v226, vcc
  buffer_store_dwordx4 v[72:75], v226, s[4:7], 0 offen sc1
  s_waitcnt vmcnt(4)
  s_branch K_S_STATIC
K_S_POS:
K_S_STATIC:
  v_and_b32 v236, 31, v1
  v_lshrrev_b32 v237, 5, v1
  v_lshlrev_b32 v235, 3, v237
  v_sub_u32 v235, v236, v235
  v_mov_b32 v228, 0x3f80
  v_mov_b32 v229, 0x3f800000
  v_cmp_eq_u32 vcc, 0, v235
  v_cmp_eq_u32 s[52:53], 1, v235
  s_nop 0
  v_cndmask_b32 v20, v200, v228, vcc
  v_cndmask_b32 v20, v20, v229, s[52:53]
  v_cmp_eq_u32 vcc, 2, v235
  v_cmp_eq_u32 s[52:53], 3, v235
  s_nop 0
  v_cndmask_b32 v21, v200, v228, vcc
  v_cndmask_b32 v21, v21, v229, s[52:53]
  v_cmp_eq_u32 vcc, 4, v235
  v_cmp_eq_u32 s[52:53], 5, v235
  s_nop 0
  v_cndmask_b32 v22, v200, v228, vcc
  v_cndmask_b32 v22, v22, v229, s[52:53]
  v_cmp_eq_u32 vcc, 6, v235
  v_cmp_eq_u32 s[52:53], 7, v235
  s_nop 0
  v_cndmask_b32 v23, v200, v228, vcc
  v_cndmask_b32 v23, v23, v229, s[52:53]
  v_cmp_eq_u32 vcc, 16, v235
  v_cmp_eq_u32 s[52:53], 17, v235
  s_nop 0
  v_cndmask_b32 v24, v200, v228, vcc
  v_cndmask_b32 v24, v24, v229, s[52:53]
  v_cmp_eq_u32 vcc, 18, v235
  v_cmp_eq_u32 s[52:53], 19, v235
  s_nop 0
  v_cndmask_b32 v25, v200, v228, vcc
  v_cndmask_b32 v25, v25, v229, s[52:53]
  v_cmp_eq_u32 vcc, 20, v235
  v_cmp_eq_u32 s[52:53], 21, v235
  s_nop 0
  v_cndmask_b32 v26, v200, v228, vcc
  v_cndmask_b32 v26, v26, v229, s[52:53]
  v_cmp_eq_u32 vcc, 22, v235
  v_cmp_eq_u32 s[52:53], 23, v235
  s_nop 0
  v_cndmask_b32 v27, v200, v228, vcc
  v_cndmask_b32 v27, v27, v229, s[52:53]
  v_cmp_lt_u32 vcc, 31, v1
  s_nop 1
  v_mov_b32 v185, 0
  v_mov_b32 v186, 0
  v_mov_b32 v187, 0
  v_cndmask_b32 v184, v228, v200, vcc
  v_mov_b32 v213, 0
  v_mov_b32 v216, 0
  v_mov_b32 v214, 0
  v_mov_b32 v217, 0
  v_mov_b32 v215, 0
  v_mov_b32 v218, 0
  v_and_b32 v236, 31, v1
  v_lshrrev_b32 v237, 5, v1
  v_mov_b32 v238, 110848
  v_lshl_add_u32 v197, v236, 6, v238
  v_bfe_u32 v235, v1, 2, 2
  v_lshl_add_u32 v235, v237, 2, v235
  v_lshl_add_u32 v196, v235, 6, v238
  v_bfe_u32 v235, v1, 4, 1
  v_lshl_add_u32 v196, v235, 5, v196
  v_and_b32 v235, 3, v1
  v_lshl_add_u32 v196, v235, 3, v196
  s_lshl_b32 s62, s32, 12
  s_add_u32 s62, s62, 127232
  s_add_u32 s48, s62, 0
  s_add_u32 s49, s62, 1024
  s_add_u32 s50, s62, 2048
  s_add_u32 s51, s62, 3072
  v_and_b32 v235, 3, v236
  v_bfe_u32 v238, v236, 4, 1
  v_lshl_or_b32 v238, v238, 2, v235
  v_lshlrev_b32 v235, 3, v235
  v_lshrrev_b32 v230, 2, v236
  v_add_u32 v235, v235, v230
  v_lshl_add_u32 v235, v235, 7, s62
  v_add_u32 v230, 0, v237
  v_xor_b32 v230, v230, v238
  v_lshl_add_u32 v188, v230, 4, v235
  v_add_u32 v230, 2, v237
  v_xor_b32 v230, v230, v238
  v_lshl_add_u32 v189, v230, 4, v235
  v_add_u32 v230, 4, v237
  v_xor_b32 v230, v230, v238
  v_lshl_add_u32 v190, v230, 4, v235
  v_add_u32 v230, 6, v237
  v_xor_b32 v230, v230, v238
  v_lshl_add_u32 v191, v230, 4, v235
  v_and_b32 v235, 7, v1
  v_lshlrev_b32 v238, 2, v237
  v_xor_b32 v235, v235, v238
  v_xor_b32 v230, 0, v235
  v_lshlrev_b32 v192, 4, v230
  v_xor_b32 v230, 1, v235
  v_lshlrev_b32 v193, 4, v230
  v_xor_b32 v230, 2, v235
  v_lshlrev_b32 v194, 4, v230
  v_xor_b32 v230, 3, v235
  v_lshlrev_b32 v195, 4, v230
  s_mov_b32 s44, 576
  s_sub_u32 s97, 11, s32
  s_cmp_lt_u32 s32, 4
  s_cselect_b32 s97, s32, s97
  v_lshrrev_b32 v232, 3, v1
  v_and_b32 v233, 7, v1
  v_lshlrev_b32 v234, 2, v232
  v_lshlrev_b32 v212, 2, v233
  s_sub_u32 s46, s32, 5
  s_cmp_lt_u32 s46, 2
  s_cbranch_scc1 K_S_PREC
  s_waitcnt vmcnt(0)
  s_cmp_lg_u32 s32, 0
  s_cbranch_scc1 K_S_PREC
  s_mov_b32 s99, 0
K_G_TAG:
  v_readfirstlane_b32 s98, v231
  v_readfirstlane_b32 s47, v202
  s_nop 3
  s_cmp_lg_u32 s98, s47
  s_cselect_b32 s46, s98, 0
  s_cmp_lg_u32 s46, 0
  s_cbranch_scc1 K_G_TAG_OK
  s_add_u32 s99, s99, 1
  s_cmp_gt_u32 s99, 200000
  s_cbranch_scc1 K_G_TAG_OK
  s_cmp_gt_u32 s99, 1000
  s_cselect_b32 s46, s98, 0
  s_cmp_lg_u32 s46, 0
  s_cbranch_scc1 K_G_TAG_OK
  buffer_load_dword v231, v200, s[92:95], s36 offen sc1
  s_waitcnt vmcnt(0)
  s_branch K_G_TAG
K_G_TAG_OK:
  v_mov_b32 v235, s98
  ds_write_b32 v200, v235 offset:168
K_S_PREC:
  s_waitcnt lgkmcnt(0)
  s_barrier
  s_cmp_lg_u32 s32, 0
  s_cbranch_scc1 K_G_NOT0
  s_lshl_b32 s46, s2, 4
  s_add_u32 s46, s46, 9990144
  v_mov_b32 v235, s98
  buffer_store_dword v235, v200, s[12:15], s46 offen sc1
  s_branch K_G_SETUP
K_G_NOT0:
  s_cmp_lt_u32 s32, 4
  s_cbranch_scc1 K_G_WH
  s_sub_u32 s46, s32, 5
  s_cmp_lt_u32 s46, 2
  s_cbranch_scc1 K_G_SETUP
  s_cmp_eq_u32 s32, 7
  s_cselect_b32 s57, 37888, 0
  s_add_u32 s46, s57, 0
  s_add_u32 s47, s46, 1280
  s_mov_b32 m0, s47
  s_nop 0
  buffer_load_dwordx4 v242, s[20:23], s46 offen lds
  s_add_u32 s46, s57, 1024
  s_add_u32 s47, s46, 1280
  s_mov_b32 m0, s47
  s_nop 0
  buffer_load_dwordx4 v242, s[20:23], s46 offen lds
  s_add_u32 s46, s57, 2048
  s_add_u32 s47, s46, 1280
  s_mov_b32 m0, s47
  s_nop 0
  buffer_load_dwordx4 v242, s[20:23], s46 offen lds
  s_add_u32 s46, s57, 3072
  s_add_u32 s47, s46, 1280
  s_mov_b32 m0, s47
  s_nop 0
  buffer_load_dwordx4 v242, s[20:23], s46 offen lds
  s_add_u32 s46, s57, 4096
  s_add_u32 s47, s46, 1280
  s_mov_b32 m0, s47
  s_nop 0
  buffer_load_dwordx4 v242, s[20:23], s46 offen lds
  s_add_u32 s46, s57, 5120
  s_add_u32 s47, s46, 1280
  s_mov_b32 m0, s47
  s_nop 0
  buffer_load_dwordx4 v242, s[20:23], s46 offen lds
  s_add_u32 s46, s57, 6144
  s_add_u32 s47, s46, 1280
  s_mov_b32 m0, s47
  s_nop 0
  buffer_load_dwordx4 v242, s[20:23], s46 offen lds
  s_add_u32 s46, s57, 7168
  s_add_u32 s47, s46, 1280
  s_mov_b32 m0, s47
  s_nop 0
  buffer_load_dwordx4 v242, s[20:23], s46 offen lds
  s_add_u32 s46, s57, 8192
  s_add_u32 s47, s46, 1280
  s_mov_b32 m0, s47
  s_nop 0
  buffer_load_dwordx4 v242, s[20:23], s46 offen lds
  s_add_u32 s46, s57, 9216
  s_add_u32 s47, s46, 1280
  s_mov_b32 m0, s47
  s_nop 0
  buffer_load_dwordx4 v242, s[20:23], s46 offen lds
  s_add_u32 s46, s57, 10240
  s_add_u32 s47, s46, 1280
  s_mov_b32 m0, s47
  s_nop 0
  buffer_load_dwordx4 v242, s[20:23], s46 offen lds
  s_add_u32 s46, s57, 11264
  s_add_u32 s47, s46, 1280
  s_mov_b32 m0, s47
  s_nop 0
  buffer_load_dwordx4 v242, s[20:23], s46 offen lds
  s_add_u32 s46, s57, 12288
  s_add_u32 s47, s46, 1280
  s_mov_b32 m0, s47
  s_nop 0
  buffer_load_dwordx4 v242, s[20:23], s46 offen lds
  s_add_u32 s46, s57, 13312
  s_add_u32 s47, s46, 1280
  s_mov_b32 m0, s47
  s_nop 0
  buffer_load_dwordx4 v242, s[20:23], s46 offen lds
  s_add_u32 s46, s57, 14336
  s_add_u32 s47, s46, 1280
  s_mov_b32 m0, s47
  s_nop 0
  buffer_load_dwordx4 v242, s[20:23], s46 offen lds
  s_add_u32 s46, s57, 15360
  s_add_u32 s47, s46, 1280
  s_mov_b32 m0, s47
  s_nop 0
  buffer_load_dwordx4 v242, s[20:23], s46 offen lds
  s_add_u32 s46, s57, 16384
  s_add_u32 s47, s46, 1280
  s_mov_b32 m0, s47
  s_nop 0
  buffer_load_dwordx4 v242, s[20:23], s46 offen lds
  s_add_u32 s46, s57, 17408
  s_add_u32 s47, s46, 1280
  s_mov_b32 m0, s47
  s_nop 0
  buffer_load_dwordx4 v242, s[20:23], s46 offen lds
  s_add_u32 s46, s57, 18432
  s_add_u32 s47, s46, 1280
  s_mov_b32 m0, s47
  s_nop 0
  buffer_load_dwordx4 v242, s[20:23], s46 offen lds
  s_add_u32 s46, s57, 19456
  s_add_u32 s47, s46, 1280
  s_mov_b32 m0, s47
  s_nop 0
  buffer_load_dwordx4 v242, s[20:23], s46 offen lds
  s_add_u32 s46, s57, 20480
  s_add_u32 s47, s46, 1280
  s_mov_b32 m0, s47
  s_nop 0
  buffer_load_dwordx4 v242, s[20:23], s46 offen lds
  s_add_u32 s46, s57, 21504
  s_add_u32 s47, s46, 1280
  s_mov_b32 m0, s47
  s_nop 0
  buffer_load_dwordx4 v242, s[20:23], s46 offen lds
  s_add_u32 s46, s57, 22528
  s_add_u32 s47, s46, 1280
  s_mov_b32 m0, s47
  s_nop 0
  buffer_load_dwordx4 v242, s[20:23], s46 offen lds
  s_add_u32 s46, s57, 23552
  s_add_u32 s47, s46, 1280
  s_mov_b32 m0, s47
  s_nop 0
  buffer_load_dwordx4 v242, s[20:23], s46 offen lds
  s_add_u32 s46, s57, 24576
  s_add_u32 s47, s46, 1280
  s_mov_b32 m0, s47
  s_nop 0
  buffer_load_dwordx4 v242, s[20:23], s46 offen lds
  s_add_u32 s46, s57, 25600
  s_add_u32 s47, s46, 1280
  s_mov_b32 m0, s47
  s_nop 0
  buffer_load_dwordx4 v242, s[20:23], s46 offen lds
  s_add_u32 s46, s57, 26624
  s_add_u32 s47, s46, 1280
  s_mov_b32 m0, s47
  s_nop 0
  buffer_load_dwordx4 v242, s[20:23], s46 offen lds
  s_add_u32 s46, s57, 27648
  s_add_u32 s47, s46, 1280
  s_mov_b32 m0, s47
  s_nop 0
  buffer_load_dwordx4 v242, s[20:23], s46 offen lds
  s_add_u32 s46, s57, 28672
  s_add_u32 s47, s46, 1280
  s_mov_b32 m0, s47
  s_nop 0
  buffer_load_dwordx4 v242, s[20:23], s46 offen lds
  s_add_u32 s46, s57, 29696
  s_add_u32 s47, s46, 1280
  s_mov_b32 m0, s47
  s_nop 0
  buffer_load_dwordx4 v242, s[20:23], s46 offen lds
  s_add_u32 s46, s57, 30720
  s_add_u32 s47, s46, 1280
  s_mov_b32 m0, s47
  s_nop 0
  buffer_load_dwordx4 v242, s[20:23], s46 offen lds
  s_add_u32 s46, s57, 31744
  s_add_u32 s47, s46, 1280
  s_mov_b32 m0, s47
  s_nop 0
  buffer_load_dwordx4 v242, s[20:23], s46 offen lds
  s_add_u32 s46, s57, 32768
  s_add_u32 s47, s46, 1280
  s_mov_b32 m0, s47
  s_nop 0
  buffer_load_dwordx4 v242, s[20:23], s46 offen lds
  s_add_u32 s46, s57, 33792
  s_add_u32 s47, s46, 1280
  s_mov_b32 m0, s47
  s_nop 0
  buffer_load_dwordx4 v242, s[20:23], s46 offen lds
  s_add_u32 s46, s57, 34816
  s_add_u32 s47, s46, 1280
  s_mov_b32 m0, s47
  s_nop 0
  buffer_load_dwordx4 v242, s[20:23], s46 offen lds
  s_add_u32 s46, s57, 35840
  s_add_u32 s47, s46, 1280
  s_mov_b32 m0, s47
  s_nop 0
  buffer_load_dwordx4 v242, s[20:23], s46 offen lds
  s_add_u32 s46, s57, 36864
  s_add_u32 s47, s46, 1280
  s_mov_b32 m0, s47
  s_nop 0
  buffer_load_dwordx4 v242, s[20:23], s46 offen lds
  s_branch K_G_SETUP
K_G_WH:
  s_load_dwordx2 s[64:65], s[0:1], 56
  s_sub_u32 s57, s32, 1
  s_waitcnt lgkmcnt(0)
  s_mov_b32 s88, s64
  s_and_b32 s89, s65, 0xffff
  s_mov_b32 s90, 16384
  s_mov_b32 s91, 0x20000
  s_add_u32 s46, s57, 0
  s_min_u32 s46, s46, 15
  s_lshl_b32 s46, s46, 10
  s_add_u32 s47, s46, 127232
  s_mov_b32 m0, s47
  s_nop 0
  buffer_load_dwordx4 v242, s[88:91], s46 offen lds
  s_add_u32 s46, s57, 3
  s_min_u32 s46, s46, 15
  s_lshl_b32 s46, s46, 10
  s_add_u32 s47, s46, 127232
  s_mov_b32 m0, s47
  s_nop 0
  buffer_load_dwordx4 v242, s[88:91], s46 offen lds
  s_add_u32 s46, s57, 6
  s_min_u32 s46, s46, 15
  s_lshl_b32 s46, s46, 10
  s_add_u32 s47, s46, 127232
  s_mov_b32 m0, s47
  s_nop 0
  buffer_load_dwordx4 v242, s[88:91], s46 offen lds
  s_add_u32 s46, s57, 9
  s_min_u32 s46, s46, 15
  s_lshl_b32 s46, s46, 10
  s_add_u32 s47, s46, 127232
  s_mov_b32 m0, s47
  s_nop 0
  buffer_load_dwordx4 v242, s[88:91], s46 offen lds
  s_add_u32 s46, s57, 12
  s_min_u32 s46, s46, 15
  s_lshl_b32 s46, s46, 10
  s_add_u32 s47, s46, 127232
  s_mov_b32 m0, s47
  s_nop 0
  buffer_load_dwordx4 v242, s[88:91], s46 offen lds
  s_add_u32 s46, s57, 15
  s_min_u32 s46, s46, 15
  s_lshl_b32 s46, s46, 10
  s_add_u32 s47, s46, 127232
  s_mov_b32 m0, s47
  s_nop 0
  buffer_load_dwordx4 v242, s[88:91], s46 offen lds
K_G_SETUP:
  v_add_u32 v235, 77056, v241
  ds_read_b64_tr_b16 v[28:29], v235 offset:0
  ds_read_b64_tr_b16 v[30:31], v235 offset:512
  ds_read_b64_tr_b16 v[32:33], v235 offset:64
  ds_read_b64_tr_b16 v[34:35], v235 offset:576
  ds_read_b64_tr_b16 v[36:37], v235 offset:2048
  ds_read_b64_tr_b16 v[38:39], v235 offset:2560
  ds_read_b64_tr_b16 v[40:41], v235 offset:2112
  ds_read_b64_tr_b16 v[42:43], v235 offset:2624
  ds_read_b64_tr_b16 v[44:45], v235 offset:4096
  ds_read_b64_tr_b16 v[46:47], v235 offset:4608
  ds_read_b64_tr_b16 v[48:49], v235 offset:4160
  ds_read_b64_tr_b16 v[50:51], v235 offset:4672
  ds_read_b64_tr_b16 v[52:53], v235 offset:6144
  ds_read_b64_tr_b16 v[54:55], v235 offset:6656
  ds_read_b64_tr_b16 v[56:57], v235 offset:6208
  ds_read_b64_tr_b16 v[58:59], v235 offset:6720
  ds_read_b64_tr_b16 v[92:93], v235 offset:16512
  ds_read_b64_tr_b16 v[94:95], v235 offset:17024
  ds_read_b64_tr_b16 v[96:97], v235 offset:16576
  ds_read_b64_tr_b16 v[98:99], v235 offset:17088
  v_mov_b32 v124, 0
  v_mov_b32 v125, 0
  v_and_b32 v236, 31, v1
  v_lshlrev_b32 v237, 1, v236
  v_add_u32 v237, 93440, v237
  ds_read_u16_d16_hi v124, v237
  ds_read_u16_d16_hi v125, v237 offset:64
  s_waitcnt lgkmcnt(0)
  v_mfma_f32_32x32x16_bf16 v[60:75], v[108:111], v[28:31], 0
  v_mfma_f32_32x32x16_bf16 v[60:75], v[112:115], v[36:39], v[60:75]
  v_mfma_f32_32x32x16_bf16 v[60:75], v[116:119], v[44:47], v[60:75]
  v_mfma_f32_32x32x16_bf16 v[60:75], v[120:123], v[52:55], v[60:75]
  v_mfma_f32_32x32x16_bf16 v[76:91], v[108:111], v[32:35], 0
  v_mfma_f32_32x32x16_bf16 v[76:91], v[112:115], v[40:43], v[76:91]
  v_mfma_f32_32x32x16_bf16 v[76:91], v[116:119], v[48:51], v[76:91]
  v_mfma_f32_32x32x16_bf16 v[76:91], v[120:123], v[56:59], v[76:91]
  s_mov_b32 s46, 3216550459
  v_lshlrev_b32 v235, 16, v92
  v_and_b32 v237, 0xffff0000, v92
  v_mul_f32 v235, s46, v235
  v_mul_f32 v237, s46, v237
  v_cvt_pk_bf16_f32 v4, v235, v237
  v_lshlrev_b32 v235, 16, v93
  v_and_b32 v237, 0xffff0000, v93
  v_mul_f32 v235, s46, v235
  v_mul_f32 v237, s46, v237
  v_cvt_pk_bf16_f32 v5, v235, v237
  v_lshlrev_b32 v235, 16, v94
  v_and_b32 v237, 0xffff0000, v94
  v_mul_f32 v235, s46, v235
  v_mul_f32 v237, s46, v237
  v_cvt_pk_bf16_f32 v6, v235, v237
  v_lshlrev_b32 v235, 16, v95
  v_and_b32 v237, 0xffff0000, v95
  v_mul_f32 v235, s46, v235
  v_mul_f32 v237, s46, v237
  v_cvt_pk_bf16_f32 v7, v235, v237
  v_lshlrev_b32 v235, 16, v96
  v_and_b32 v237, 0xffff0000, v96
  v_mul_f32 v235, s46, v235
  v_mul_f32 v237, s46, v237
  v_cvt_pk_bf16_f32 v8, v235, v237
  v_lshlrev_b32 v235, 16, v97
  v_and_b32 v237, 0xffff0000, v97
  v_mul_f32 v235, s46, v235
  v_mul_f32 v237, s46, v237
  v_cvt_pk_bf16_f32 v9, v235, v237
  v_lshlrev_b32 v235, 16, v98
  v_and_b32 v237, 0xffff0000, v98
  v_mul_f32 v235, s46, v235
  v_mul_f32 v237, s46, v237
  v_cvt_pk_bf16_f32 v10, v235, v237
  v_lshlrev_b32 v235, 16, v99
  v_and_b32 v237, 0xffff0000, v99
  v_mul_f32 v235, s46, v235
  v_mul_f32 v237, s46, v237
  v_cvt_pk_bf16_f32 v11, v235, v237
  v_cmp_lt_u32 vcc, 31, v1
  v_mul_f32 v124, s46, v124
  v_cvt_pk_bf16_f32 v235, v124, v124
  v_and_b32 v235, 0xffff0000, v235
  v_sub_f32 v237, v124, v235
  v_cvt_pk_bf16_f32 v237, v237, v237
  v_and_b32 v237, 0xffff0000, v237
  v_cndmask_b32 v124, v235, v237, vcc
  v_mul_f32 v125, s46, v125
  v_cvt_pk_bf16_f32 v235, v125, v125
  v_and_b32 v235, 0xffff0000, v235
  v_sub_f32 v237, v125, v235
  v_cvt_pk_bf16_f32 v237, v237, v237
  v_and_b32 v237, 0xffff0000, v237
  v_cndmask_b32 v125, v235, v237, vcc
  s_cmp_lg_u32 s32, 0
  s_cbranch_scc1 K_G_NOEARLY
  s_mov_b32 s47, 9990144
  buffer_load_dword v226, v242, s[12:15], s47 offen offset:0 sc1
  buffer_load_dword v227, v242, s[12:15], s47 offen offset:1024 sc1
  buffer_load_dword v228, v242, s[12:15], s47 offen offset:2048 sc1
  buffer_load_dword v229, v242, s[12:15], s47 offen offset:3072 sc1
K_G_NOEARLY:
  v_cmp_lt_u32 vcc, 31, v1
  v_mov_b32 v230, 0xffff
  v_mul_f32 v60, s46, v60
  v_mul_f32 v61, s46, v61
  v_cvt_pk_bf16_f32 v235, v60, v61
  v_lshlrev_b32 v236, 16, v235
  v_and_b32 v237, 0xffff0000, v235
  v_sub_f32 v236, v60, v236
  v_sub_f32 v237, v61, v237
  v_cvt_pk_bf16_f32 v236, v236, v237
  v_cndmask_b32 v12, v235, v236, vcc
  v_mul_f32 v62, s46, v62
  v_mul_f32 v63, s46, v63
  v_cvt_pk_bf16_f32 v235, v62, v63
  v_lshlrev_b32 v236, 16, v235
  v_and_b32 v237, 0xffff0000, v235
  v_sub_f32 v236, v62, v236
  v_sub_f32 v237, v63, v237
  v_cvt_pk_bf16_f32 v236, v236, v237
  v_cndmask_b32 v13, v235, v236, vcc
  v_mul_f32 v64, s46, v64
  v_mul_f32 v65, s46, v65
  v_cvt_pk_bf16_f32 v235, v64, v65
  v_lshlrev_b32 v236, 16, v235
  v_and_b32 v237, 0xffff0000, v235
  v_sub_f32 v236, v64, v236
  v_sub_f32 v237, v65, v237
  v_cvt_pk_bf16_f32 v236, v236, v237
  v_cndmask_b32 v14, v235, v236, vcc
  v_mul_f32 v66, s46, v66
  v_mul_f32 v67, s46, v67
  v_cvt_pk_bf16_f32 v235, v66, v67
  v_lshlrev_b32 v236, 16, v235
  v_and_b32 v237, 0xffff0000, v235
  v_sub_f32 v236, v66, v236
  v_sub_f32 v237, v67, v237
  v_cvt_pk_bf16_f32 v236, v236, v237
  v_cndmask_b32 v15, v235, v236, vcc
  v_bfi_b32 v15, v230, v15, v124
  v_mul_f32 v76, s46, v76
  v_mul_f32 v77, s46, v77
  v_cvt_pk_bf16_f32 v235, v76, v77
  v_lshlrev_b32 v236, 16, v235
  v_and_b32 v237, 0xffff0000, v235
  v_sub_f32 v236, v76, v236
  v_sub_f32 v237, v77, v237
  v_cvt_pk_bf16_f32 v236, v236, v237
  v_cndmask_b32 v16, v235, v236, vcc
  v_mul_f32 v78, s46, v78
  v_mul_f32 v79, s46, v79
  v_cvt_pk_bf16_f32 v235, v78, v79
  v_lshlrev_b32 v236, 16, v235
  v_and_b32 v237, 0xffff0000, v235
  v_sub_f32 v236, v78, v236
  v_sub_f32 v237, v79, v237
  v_cvt_pk_bf16_f32 v236, v236, v237
  v_cndmask_b32 v17, v235, v236, vcc
  v_mul_f32 v80, s46, v80
  v_mul_f32 v81, s46, v81
  v_cvt_pk_bf16_f32 v235, v80, v81
  v_lshlrev_b32 v236, 16, v235
  v_and_b32 v237, 0xffff0000, v235
  v_sub_f32 v236, v80, v236
  v_sub_f32 v237, v81, v237
  v_cvt_pk_bf16_f32 v236, v236, v237
  v_cndmask_b32 v18, v235, v236, vcc
  v_mul_f32 v82, s46, v82
  v_mul_f32 v83, s46, v83
  v_cvt_pk_bf16_f32 v235, v82, v83
  v_lshlrev_b32 v236, 16, v235
  v_and_b32 v237, 0xffff0000, v235
  v_sub_f32 v236, v82, v236
  v_sub_f32 v237, v83, v237
  v_cvt_pk_bf16_f32 v236, v236, v237
  v_cndmask_b32 v19, v235, v236, vcc
  v_bfi_b32 v19, v230, v19, v125
  s_lshl_b32 s46, s32, 11
  s_add_u32 s46, s46, 110848
  v_lshl_add_u32 v235, v1, 5, s46
  ds_write_b128 v235, v[12:15]
  ds_write_b128 v235, v[16:19] offset:16
  v_mov_b32 v28, 0
  v_mov_b32 v29, 0
  v_mov_b32 v30, 0
  v_mov_b32 v31, 0
  v_mov_b32 v32, 0
  v_mov_b32 v33, 0
  v_mov_b32 v34, 0
  v_mov_b32 v35, 0
  v_mov_b32 v36, 0
  v_mov_b32 v37, 0
  v_mov_b32 v38, 0
  v_mov_b32 v39, 0
  v_mov_b32 v40, 0
  v_mov_b32 v41, 0
  v_mov_b32 v42, 0
  v_mov_b32 v43, 0
  v_mov_b32 v44, 0
  v_mov_b32 v45, 0
  v_mov_b32 v46, 0
  v_mov_b32 v47, 0
  v_mov_b32 v48, 0
  v_mov_b32 v49, 0
  v_mov_b32 v50, 0
  v_mov_b32 v51, 0
  v_mov_b32 v52, 0
  v_mov_b32 v53, 0
  v_mov_b32 v54, 0
  v_mov_b32 v55, 0
  v_mov_b32 v56, 0
  v_mov_b32 v57, 0
  v_mov_b32 v58, 0
  v_mov_b32 v59, 0
  s_sub_u32 s46, s32, 5
  s_cmp_lt_u32 s46, 2
  s_cbranch_scc0 K_G_NOFLG2
  ds_read_b32 v231, v200 offset:168
  s_waitcnt vmcnt(0) lgkmcnt(0)
  v_readfirstlane_b32 s98, v231
  s_nop 3
  s_lshl_b32 s46, s2, 1
  s_add_u32 s46, s46, s32
  s_sub_u32 s46, s46, 5
  s_lshl_b32 s46, s46, 4
  s_add_u32 s46, s46, 9994240
  v_mov_b32 v235, s98
  buffer_store_dword v235, v200, s[12:15], s46 offen sc1
K_G_NOFLG2:
  s_cmp_lg_u32 s32, 0
  s_cbranch_scc1 K_G_WAIT
  s_branch K_G_POLL1
K_G_POLL:
  s_mov_b32 s47, 9990144
  buffer_load_dword v226, v242, s[12:15], s47 offen offset:0 sc1
  buffer_load_dword v227, v242, s[12:15], s47 offen offset:1024 sc1
  buffer_load_dword v228, v242, s[12:15], s47 offen offset:2048 sc1
  buffer_load_dword v229, v242, s[12:15], s47 offen offset:3072 sc1
K_G_POLL1:
  s_waitcnt vmcnt(0)
  v_cmp_eq_u32 s[54:55], s98, v226
  v_cmp_eq_u32 vcc, s98, v227
  s_nop 1
  s_and_b64 s[54:55], s[54:55], vcc
  v_cmp_eq_u32 vcc, s98, v228
  s_nop 1
  s_and_b64 s[54:55], s[54:55], vcc
  v_cmp_eq_u32 vcc, s98, v229
  s_nop 1
  s_and_b64 s[54:55], s[54:55], vcc
  s_cmp_eq_u64 s[54:55], -1
  s_cbranch_scc1 K_G_WAIT
  s_add_u32 s99, s99, 1
  s_cmp_lt_u32 s99, 200000
  s_cbranch_scc1 K_G_POLL
K_G_WAIT:
  s_lshl_b32 s46, 1, s32
  s_and_b32 s46, s46, 0x90
  s_cbranch_scc1 K_G_WAIT47
  s_waitcnt vmcnt(0)
K_G_WAIT47:
  s_waitcnt lgkmcnt(0)
K_G_GO:
  s_barrier
  s_lshl_b32 s46, s2, 15
  s_lshl_b32 s47, s32, 9
  s_add_u32 s46, s46, s47
  v_lshl_add_u32 v235, v1, 3, s46
  s_mov_b32 s37, 0
  s_add_u32 s46, s37, 0
  s_and_b32 s46, s46, 7
  s_lshl_b32 s46, s46, 12
  buffer_load_dwordx2 v[60:61], v235, s[12:15], s46 offen sc1
  s_add_u32 s46, s37, 1
  s_and_b32 s46, s46, 7
  s_lshl_b32 s46, s46, 12
  buffer_load_dwordx2 v[62:63], v235, s[12:15], s46 offen sc1
  s_add_u32 s46, s37, 2
  s_and_b32 s46, s46, 7
  s_lshl_b32 s46, s46, 12
  buffer_load_dwordx2 v[64:65], v235, s[12:15], s46 offen sc1
  s_add_u32 s46, s37, 3
  s_and_b32 s46, s46, 7
  s_lshl_b32 s46, s46, 12
  buffer_load_dwordx2 v[66:67], v235, s[12:15], s46 offen sc1
  s_add_u32 s46, s37, 4
  s_and_b32 s46, s46, 7
  s_lshl_b32 s46, s46, 12
  buffer_load_dwordx2 v[68:69], v235, s[12:15], s46 offen sc1
  s_add_u32 s46, s37, 5
  s_and_b32 s46, s46, 7
  s_lshl_b32 s46, s46, 12
  buffer_load_dwordx2 v[70:71], v235, s[12:15], s46 offen sc1
  s_add_u32 s46, s37, 6
  s_and_b32 s46, s46, 7
  s_lshl_b32 s46, s46, 12
  buffer_load_dwordx2 v[72:73], v235, s[12:15], s46 offen sc1
  s_add_u32 s46, s37, 7
  s_and_b32 s46, s46, 7
  s_lshl_b32 s46, s46, 12
  buffer_load_dwordx2 v[74:75], v235, s[12:15], s46 offen sc1
  v_lshlrev_b32 v237, 1, v1
  v_and_b32 v237, 62, v237
  s_load_dwordx2 s[98:99], s[0:1], 48
  s_and_b32 s46, s32, 1
  s_lshl_b32 s46, s46, 6
  s_add_u32 s46, s46, 127232
  v_add_u32 v236, s46, v241
  ds_read_b64_tr_b16 v[152:153], v236 offset:0
  ds_read_b64_tr_b16 v[154:155], v236 offset:512
  ds_read_b64_tr_b16 v[156:157], v236 offset:2048
  ds_read_b64_tr_b16 v[158:159], v236 offset:2560
  ds_read_b64_tr_b16 v[160:161], v236 offset:4096
  ds_read_b64_tr_b16 v[162:163], v236 offset:4608
  ds_read_b64_tr_b16 v[164:165], v236 offset:6144
  ds_read_b64_tr_b16 v[166:167], v236 offset:6656
  s_waitcnt lgkmcnt(0)
  ds_read_b64_tr_b16 v[168:169], v236 offset:8192
  ds_read_b64_tr_b16 v[170:171], v236 offset:8704
  ds_read_b64_tr_b16 v[172:173], v236 offset:10240
  ds_read_b64_tr_b16 v[174:175], v236 offset:10752
  ds_read_b64_tr_b16 v[176:177], v236 offset:12288
  ds_read_b64_tr_b16 v[178:179], v236 offset:12800
  ds_read_b64_tr_b16 v[180:181], v236 offset:14336
  ds_read_b64_tr_b16 v[182:183], v236 offset:14848
  s_mov_b32 s84, s98
  s_and_b32 s85, s99, 0xffff
  s_mov_b32 s86, 128
  s_mov_b32 s87, 0x20000
  v_mov_b32 v243, 0
  v_mov_b32 v244, 0
  buffer_load_short_d16_hi v243, v237, s[84:87], 0 offen
  buffer_load_short_d16_hi v244, v237, s[84:87], 0 offen offset:64
  s_waitcnt vmcnt(2)
  s_mov_b64 s[54:55], 0
  v_cmp_gt_u32 s[64:65], s60, v60
  v_cmp_eq_u32 vcc, s60, v60
  v_lshrrev_b32 v76, 27, v60
  v_and_b32 v76, 0x1c, v76
  s_or_b64 s[54:55], s[54:55], vcc
  v_cmp_gt_u32 s[66:67], s60, v62
  v_cmp_eq_u32 vcc, s60, v62
  v_lshrrev_b32 v77, 27, v62
  v_and_b32 v77, 0x1c, v77
  s_or_b64 s[54:55], s[54:55], vcc
  v_cmp_gt_u32 s[68:69], s60, v64
  v_cmp_eq_u32 vcc, s60, v64
  v_lshrrev_b32 v78, 27, v64
  v_and_b32 v78, 0x1c, v78
  s_or_b64 s[54:55], s[54:55], vcc
  v_cmp_gt_u32 s[70:71], s60, v66
  v_cmp_eq_u32 vcc, s60, v66
  v_lshrrev_b32 v79, 27, v66
  v_and_b32 v79, 0x1c, v79
  s_or_b64 s[54:55], s[54:55], vcc
  v_cmp_gt_u32 s[72:73], s60, v68
  v_cmp_eq_u32 vcc, s60, v68
  v_lshrrev_b32 v80, 27, v68
  v_and_b32 v80, 0x1c, v80
  s_or_b64 s[54:55], s[54:55], vcc
  v_cmp_gt_u32 s[74:75], s60, v70
  v_cmp_eq_u32 vcc, s60, v70
  v_lshrrev_b32 v81, 27, v70
  v_and_b32 v81, 0x1c, v81
  s_or_b64 s[54:55], s[54:55], vcc
  v_cmp_gt_u32 s[76:77], s60, v72
  v_cmp_eq_u32 vcc, s60, v72
  v_lshrrev_b32 v82, 27, v72
  v_and_b32 v82, 0x1c, v82
  s_or_b64 s[54:55], s[54:55], vcc
  v_cmp_gt_u32 s[78:79], s60, v74
  v_cmp_eq_u32 vcc, s60, v74
  v_lshrrev_b32 v83, 27, v74
  v_and_b32 v83, 0x1c, v83
  s_or_b64 s[54:55], s[54:55], vcc
  v_cmp_gt_u32 s[80:81], s60, v61
  v_lshrrev_b32 v84, 27, v61
  v_and_b32 v84, 0x1c, v84
  v_cmp_gt_u32 s[82:83], s60, v63
  v_lshrrev_b32 v85, 27, v63
  v_and_b32 v85, 0x1c, v85
  v_cmp_gt_u32 s[84:85], s60, v65
  v_lshrrev_b32 v86, 27, v65
  v_and_b32 v86, 0x1c, v86
  v_cmp_gt_u32 s[86:87], s60, v67
  v_lshrrev_b32 v87, 27, v67
  v_and_b32 v87, 0x1c, v87
  v_cmp_gt_u32 s[88:89], s60, v69
  v_lshrrev_b32 v88, 27, v69
  v_and_b32 v88, 0x1c, v88
  v_cmp_gt_u32 s[90:91], s60, v71
  v_lshrrev_b32 v89, 27, v71
  v_and_b32 v89, 0x1c, v89
  v_cmp_gt_u32 s[92:93], s60, v73
  v_lshrrev_b32 v90, 27, v73
  v_and_b32 v90, 0x1c, v90
  v_cmp_gt_u32 s[94:95], s60, v75
  v_lshrrev_b32 v91, 27, v75
  v_and_b32 v91, 0x1c, v91
  s_mov_b64 exec, s[64:65]
  ds_add_rtn_u32 v92, v76, v239 offset:128
  s_mov_b64 exec, s[80:81]
  s_cbranch_execz K2_A8
  ds_add_rtn_u32 v100, v84, v239 offset:128
K2_A8:
  s_mov_b64 exec, s[66:67]
  ds_add_rtn_u32 v93, v77, v239 offset:128
  s_mov_b64 exec, s[82:83]
  s_cbranch_execz K2_A9
  ds_add_rtn_u32 v101, v85, v239 offset:128
K2_A9:
  s_mov_b64 exec, s[68:69]
  ds_add_rtn_u32 v94, v78, v239 offset:128
  s_mov_b64 exec, s[84:85]
  s_cbranch_execz K2_A10
  ds_add_rtn_u32 v102, v86, v239 offset:128
K2_A10:
  s_mov_b64 exec, s[70:71]
  ds_add_rtn_u32 v95, v79, v239 offset:128
  s_mov_b64 exec, s[86:87]
  s_cbranch_execz K2_A11
  ds_add_rtn_u32 v103, v87, v239 offset:128
K2_A11:
  s_waitcnt lgkmcnt(4)
  s_mov_b64 exec, s[72:73]
  ds_add_rtn_u32 v96, v80, v239 offset:128
  s_mov_b64 exec, s[88:89]
  s_cbranch_execz K2_A12
  ds_add_rtn_u32 v104, v88, v239 offset:128
K2_A12:
  s_mov_b64 exec, s[74:75]
  ds_add_rtn_u32 v97, v81, v239 offset:128
  s_mov_b64 exec, s[90:91]
  s_cbranch_execz K2_A13
  ds_add_rtn_u32 v105, v89, v239 offset:128
K2_A13:
  s_mov_b64 exec, s[76:77]
  ds_add_rtn_u32 v98, v82, v239 offset:128
  s_mov_b64 exec, s[92:93]
  s_cbranch_execz K2_A14
  ds_add_rtn_u32 v106, v90, v239 offset:128
K2_A14:
  s_mov_b64 exec, s[78:79]
  ds_add_rtn_u32 v99, v83, v239 offset:128
  s_mov_b64 exec, s[94:95]
  s_cbranch_execz K2_A15
  ds_add_rtn_u32 v107, v91, v239 offset:128
K2_A15:
  s_mov_b64 exec, -1
  s_cmp_lg_u32 s32, 1
  s_cbranch_scc1 K2_NOF2A
  s_mov_b32 s47, 9994240
  buffer_load_dword v132, v242, s[12:15], s47 offen offset:0 sc1
  buffer_load_dword v133, v242, s[12:15], s47 offen offset:1024 sc1
  buffer_load_dword v134, v242, s[12:15], s47 offen offset:2048 sc1
  buffer_load_dword v135, v242, s[12:15], s47 offen offset:3072 sc1
  s_mov_b32 s47, 9998336
  buffer_load_dword v136, v242, s[12:15], s47 offen offset:0 sc1
  buffer_load_dword v137, v242, s[12:15], s47 offen offset:1024 sc1
  buffer_load_dword v138, v242, s[12:15], s47 offen offset:2048 sc1
  buffer_load_dword v139, v242, s[12:15], s47 offen offset:3072 sc1
  ds_read_b32 v231, v200 offset:168
K2_NOF2A:
  s_lshl_b32 s46, s32, 2
  v_lshrrev_b32 v235, 4, v1
  v_add_u32 v235, s46, v235
  v_mul_u32_u24 v235, 3136, v235
  s_lshl_b32 s46, s32, 2
  v_lshrrev_b32 v235, 4, v1
  v_add_u32 v235, s46, v235
  v_mul_u32_u24 v235, 3136, v235
  v_mov_b32 v237, 0x2000000
  v_cmp_gt_u32 vcc, s60, v60
  v_and_b32 v236, 0xfff, v60
  s_add_u32 s46, s37, 0
  s_and_b32 s46, s46, 7
  s_mul_i32 s46, s46, 100352
  v_add3_u32 v236, v236, v235, s46
  s_nop 0
  v_cndmask_b32 v236, v237, v236, vcc
  v_lshlrev_b32 v236, 5, v236
  buffer_load_dword v245, v236, s[8:11], 0 offen
  s_lshl_b32 s46, s32, 2
  v_lshrrev_b32 v235, 4, v1
  v_add_u32 v235, s46, v235
  v_mul_u32_u24 v235, 3136, v235
  v_mov_b32 v236, 77056
  v_mov_b32 v237, 99584
  s_waitcnt lgkmcnt(0)
  s_mov_b64 exec, s[64:65]
  s_add_u32 s46, s37, 0
  s_and_b32 s46, s46, 7
  s_mul_i32 s46, s46, 100352
  v_min_u32 v92, 703, v92
  v_and_b32 v238, 0xfff, v60
  v_mad_u32_u24 v92, v76, s61, v92
  v_add3_u32 v238, v238, v235, s46
  v_bfe_u32 v230, v60, 26, 3
  v_lshl_add_u32 v226, v92, 2, v236
  v_lshl_or_b32 v238, v238, 5, v230
  v_lshl_add_u32 v227, v92, 1, v237
  v_bfe_u32 v230, v60, 12, 14
  ds_write_b32 v226, v238
  ds_write_b16 v227, v230
  s_mov_b64 exec, s[80:81]
  s_cbranch_execz K2_B8
  s_add_u32 s46, s37, 0
  s_and_b32 s46, s46, 7
  s_mul_i32 s46, s46, 100352
  v_min_u32 v100, 703, v100
  v_and_b32 v238, 0xfff, v61
  v_mad_u32_u24 v100, v84, s61, v100
  v_add3_u32 v238, v238, v235, s46
  v_bfe_u32 v230, v61, 26, 3
  v_lshl_add_u32 v226, v100, 2, v236
  v_lshl_or_b32 v238, v238, 5, v230
  v_lshl_add_u32 v227, v100, 1, v237
  v_bfe_u32 v230, v61, 12, 14
  ds_write_b32 v226, v238
  ds_write_b16 v227, v230
K2_B8:
  s_mov_b64 exec, s[66:67]
  s_add_u32 s46, s37, 1
  s_and_b32 s46, s46, 7
  s_mul_i32 s46, s46, 100352
  v_min_u32 v93, 703, v93
  v_and_b32 v238, 0xfff, v62
  v_mad_u32_u24 v93, v77, s61, v93
  v_add3_u32 v238, v238, v235, s46
  v_bfe_u32 v230, v62, 26, 3
  v_lshl_add_u32 v226, v93, 2, v236
  v_lshl_or_b32 v238, v238, 5, v230
  v_lshl_add_u32 v227, v93, 1, v237
  v_bfe_u32 v230, v62, 12, 14
  ds_write_b32 v226, v238
  ds_write_b16 v227, v230
  s_mov_b64 exec, s[82:83]
  s_cbranch_execz K2_B9
  s_add_u32 s46, s37, 1
  s_and_b32 s46, s46, 7
  s_mul_i32 s46, s46, 100352
  v_min_u32 v101, 703, v101
  v_and_b32 v238, 0xfff, v63
  v_mad_u32_u24 v101, v85, s61, v101
  v_add3_u32 v238, v238, v235, s46
  v_bfe_u32 v230, v63, 26, 3
  v_lshl_add_u32 v226, v101, 2, v236
  v_lshl_or_b32 v238, v238, 5, v230
  v_lshl_add_u32 v227, v101, 1, v237
  v_bfe_u32 v230, v63, 12, 14
  ds_write_b32 v226, v238
  ds_write_b16 v227, v230
K2_B9:
  s_mov_b64 exec, s[68:69]
  s_add_u32 s46, s37, 2
  s_and_b32 s46, s46, 7
  s_mul_i32 s46, s46, 100352
  v_min_u32 v94, 703, v94
  v_and_b32 v238, 0xfff, v64
  v_mad_u32_u24 v94, v78, s61, v94
  v_add3_u32 v238, v238, v235, s46
  v_bfe_u32 v230, v64, 26, 3
  v_lshl_add_u32 v226, v94, 2, v236
  v_lshl_or_b32 v238, v238, 5, v230
  v_lshl_add_u32 v227, v94, 1, v237
  v_bfe_u32 v230, v64, 12, 14
  ds_write_b32 v226, v238
  ds_write_b16 v227, v230
  s_mov_b64 exec, s[84:85]
  s_cbranch_execz K2_B10
  s_add_u32 s46, s37, 2
  s_and_b32 s46, s46, 7
  s_mul_i32 s46, s46, 100352
  v_min_u32 v102, 703, v102
  v_and_b32 v238, 0xfff, v65
  v_mad_u32_u24 v102, v86, s61, v102
  v_add3_u32 v238, v238, v235, s46
  v_bfe_u32 v230, v65, 26, 3
  v_lshl_add_u32 v226, v102, 2, v236
  v_lshl_or_b32 v238, v238, 5, v230
  v_lshl_add_u32 v227, v102, 1, v237
  v_bfe_u32 v230, v65, 12, 14
  ds_write_b32 v226, v238
  ds_write_b16 v227, v230
K2_B10:
  s_mov_b64 exec, s[70:71]
  s_add_u32 s46, s37, 3
  s_and_b32 s46, s46, 7
  s_mul_i32 s46, s46, 100352
  v_min_u32 v95, 703, v95
  v_and_b32 v238, 0xfff, v66
  v_mad_u32_u24 v95, v79, s61, v95
  v_add3_u32 v238, v238, v235, s46
  v_bfe_u32 v230, v66, 26, 3
  v_lshl_add_u32 v226, v95, 2, v236
  v_lshl_or_b32 v238, v238, 5, v230
  v_lshl_add_u32 v227, v95, 1, v237
  v_bfe_u32 v230, v66, 12, 14
  ds_write_b32 v226, v238
  ds_write_b16 v227, v230
  s_mov_b64 exec, s[86:87]
  s_cbranch_execz K2_B11
  s_add_u32 s46, s37, 3
  s_and_b32 s46, s46, 7
  s_mul_i32 s46, s46, 100352
  v_min_u32 v103, 703, v103
  v_and_b32 v238, 0xfff, v67
  v_mad_u32_u24 v103, v87, s61, v103
  v_add3_u32 v238, v238, v235, s46
  v_bfe_u32 v230, v67, 26, 3
  v_lshl_add_u32 v226, v103, 2, v236
  v_lshl_or_b32 v238, v238, 5, v230
  v_lshl_add_u32 v227, v103, 1, v237
  v_bfe_u32 v230, v67, 12, 14
  ds_write_b32 v226, v238
  ds_write_b16 v227, v230
K2_B11:
  s_mov_b64 exec, s[72:73]
  s_add_u32 s46, s37, 4
  s_and_b32 s46, s46, 7
  s_mul_i32 s46, s46, 100352
  v_min_u32 v96, 703, v96
  v_and_b32 v238, 0xfff, v68
  v_mad_u32_u24 v96, v80, s61, v96
  v_add3_u32 v238, v238, v235, s46
  v_bfe_u32 v230, v68, 26, 3
  v_lshl_add_u32 v226, v96, 2, v236
  v_lshl_or_b32 v238, v238, 5, v230
  v_lshl_add_u32 v227, v96, 1, v237
  v_bfe_u32 v230, v68, 12, 14
  ds_write_b32 v226, v238
  ds_write_b16 v227, v230
  s_mov_b64 exec, s[88:89]
  s_cbranch_execz K2_B12
  s_add_u32 s46, s37, 4
  s_and_b32 s46, s46, 7
  s_mul_i32 s46, s46, 100352
  v_min_u32 v104, 703, v104
  v_and_b32 v238, 0xfff, v69
  v_mad_u32_u24 v104, v88, s61, v104
  v_add3_u32 v238, v238, v235, s46
  v_bfe_u32 v230, v69, 26, 3
  v_lshl_add_u32 v226, v104, 2, v236
  v_lshl_or_b32 v238, v238, 5, v230
  v_lshl_add_u32 v227, v104, 1, v237
  v_bfe_u32 v230, v69, 12, 14
  ds_write_b32 v226, v238
  ds_write_b16 v227, v230
K2_B12:
  s_mov_b64 exec, s[74:75]
  s_add_u32 s46, s37, 5
  s_and_b32 s46, s46, 7
  s_mul_i32 s46, s46, 100352
  v_min_u32 v97, 703, v97
  v_and_b32 v238, 0xfff, v70
  v_mad_u32_u24 v97, v81, s61, v97
  v_add3_u32 v238, v238, v235, s46
  v_bfe_u32 v230, v70, 26, 3
  v_lshl_add_u32 v226, v97, 2, v236
  v_lshl_or_b32 v238, v238, 5, v230
  v_lshl_add_u32 v227, v97, 1, v237
  v_bfe_u32 v230, v70, 12, 14
  ds_write_b32 v226, v238
  ds_write_b16 v227, v230
  s_mov_b64 exec, s[90:91]
  s_cbranch_execz K2_B13
  s_add_u32 s46, s37, 5
  s_and_b32 s46, s46, 7
  s_mul_i32 s46, s46, 100352
  v_min_u32 v105, 703, v105
  v_and_b32 v238, 0xfff, v71
  v_mad_u32_u24 v105, v89, s61, v105
  v_add3_u32 v238, v238, v235, s46
  v_bfe_u32 v230, v71, 26, 3
  v_lshl_add_u32 v226, v105, 2, v236
  v_lshl_or_b32 v238, v238, 5, v230
  v_lshl_add_u32 v227, v105, 1, v237
  v_bfe_u32 v230, v71, 12, 14
  ds_write_b32 v226, v238
  ds_write_b16 v227, v230
K2_B13:
  s_mov_b64 exec, s[76:77]
  s_add_u32 s46, s37, 6
  s_and_b32 s46, s46, 7
  s_mul_i32 s46, s46, 100352
  v_min_u32 v98, 703, v98
  v_and_b32 v238, 0xfff, v72
  v_mad_u32_u24 v98, v82, s61, v98
  v_add3_u32 v238, v238, v235, s46
  v_bfe_u32 v230, v72, 26, 3
  v_lshl_add_u32 v226, v98, 2, v236
  v_lshl_or_b32 v238, v238, 5, v230
  v_lshl_add_u32 v227, v98, 1, v237
  v_bfe_u32 v230, v72, 12, 14
  ds_write_b32 v226, v238
  ds_write_b16 v227, v230
  s_mov_b64 exec, s[92:93]
  s_cbranch_execz K2_B14
  s_add_u32 s46, s37, 6
  s_and_b32 s46, s46, 7
  s_mul_i32 s46, s46, 100352
  v_min_u32 v106, 703, v106
  v_and_b32 v238, 0xfff, v73
  v_mad_u32_u24 v106, v90, s61, v106
  v_add3_u32 v238, v238, v235, s46
  v_bfe_u32 v230, v73, 26, 3
  v_lshl_add_u32 v226, v106, 2, v236
  v_lshl_or_b32 v238, v238, 5, v230
  v_lshl_add_u32 v227, v106, 1, v237
  v_bfe_u32 v230, v73, 12, 14
  ds_write_b32 v226, v238
  ds_write_b16 v227, v230
K2_B14:
  s_mov_b64 exec, s[78:79]
  s_add_u32 s46, s37, 7
  s_and_b32 s46, s46, 7
  s_mul_i32 s46, s46, 100352
  v_min_u32 v99, 703, v99
  v_and_b32 v238, 0xfff, v74
  v_mad_u32_u24 v99, v83, s61, v99
  v_add3_u32 v238, v238, v235, s46
  v_bfe_u32 v230, v74, 26, 3
  v_lshl_add_u32 v226, v99, 2, v236
  v_lshl_or_b32 v238, v238, 5, v230
  v_lshl_add_u32 v227, v99, 1, v237
  v_bfe_u32 v230, v74, 12, 14
  ds_write_b32 v226, v238
  ds_write_b16 v227, v230
  s_mov_b64 exec, s[94:95]
  s_cbranch_execz K2_B15
  s_add_u32 s46, s37, 7
  s_and_b32 s46, s46, 7
  s_mul_i32 s46, s46, 100352
  v_min_u32 v107, 703, v107
  v_and_b32 v238, 0xfff, v75
  v_mad_u32_u24 v107, v91, s61, v107
  v_add3_u32 v238, v238, v235, s46
  v_bfe_u32 v230, v75, 26, 3
  v_lshl_add_u32 v226, v107, 2, v236
  v_lshl_or_b32 v238, v238, 5, v230
  v_lshl_add_u32 v227, v107, 1, v237
  v_bfe_u32 v230, v75, 12, 14
  ds_write_b32 v226, v238
  ds_write_b16 v227, v230
K2_B15:
  s_mov_b64 exec, -1
  s_cmp_eq_u64 s[54:55], 0
  s_cbranch_scc1 K2_NOMARK
  v_lshrrev_b32 v235, 4, v1
  s_lshl_b32 s46, s32, 2
  v_add_u32 v235, s46, v235
  v_mov_b32 v236, 160
  v_cmp_eq_u32 vcc, s60, v60
  s_and_saveexec_b64 s[52:53], vcc
  s_cbranch_execz K2_MK0
  ds_add_rtn_u32 v237, v236, v239
  s_add_u32 s46, s37, 0
  s_and_b32 s46, s46, 7
  s_lshl_b32 s46, s46, 5
  v_add_u32 v238, s46, v235
  s_waitcnt lgkmcnt(0)
  v_lshlrev_b32 v237, 2, v237
  ds_write_b32 v237, v238 offset:256
K2_MK0:
  s_mov_b64 exec, s[52:53]
  v_cmp_eq_u32 vcc, s60, v62
  s_and_saveexec_b64 s[52:53], vcc
  s_cbranch_execz K2_MK1
  ds_add_rtn_u32 v237, v236, v239
  s_add_u32 s46, s37, 1
  s_and_b32 s46, s46, 7
  s_lshl_b32 s46, s46, 5
  v_add_u32 v238, s46, v235
  s_waitcnt lgkmcnt(0)
  v_lshlrev_b32 v237, 2, v237
  ds_write_b32 v237, v238 offset:256
K2_MK1:
  s_mov_b64 exec, s[52:53]
  v_cmp_eq_u32 vcc, s60, v64
  s_and_saveexec_b64 s[52:53], vcc
  s_cbranch_execz K2_MK2
  ds_add_rtn_u32 v237, v236, v239
  s_add_u32 s46, s37, 2
  s_and_b32 s46, s46, 7
  s_lshl_b32 s46, s46, 5
  v_add_u32 v238, s46, v235
  s_waitcnt lgkmcnt(0)
  v_lshlrev_b32 v237, 2, v237
  ds_write_b32 v237, v238 offset:256
K2_MK2:
  s_mov_b64 exec, s[52:53]
  v_cmp_eq_u32 vcc, s60, v66
  s_and_saveexec_b64 s[52:53], vcc
  s_cbranch_execz K2_MK3
  ds_add_rtn_u32 v237, v236, v239
  s_add_u32 s46, s37, 3
  s_and_b32 s46, s46, 7
  s_lshl_b32 s46, s46, 5
  v_add_u32 v238, s46, v235
  s_waitcnt lgkmcnt(0)
  v_lshlrev_b32 v237, 2, v237
  ds_write_b32 v237, v238 offset:256
K2_MK3:
  s_mov_b64 exec, s[52:53]
  v_cmp_eq_u32 vcc, s60, v68
  s_and_saveexec_b64 s[52:53], vcc
  s_cbranch_execz K2_MK4
  ds_add_rtn_u32 v237, v236, v239
  s_add_u32 s46, s37, 4
  s_and_b32 s46, s46, 7
  s_lshl_b32 s46, s46, 5
  v_add_u32 v238, s46, v235
  s_waitcnt lgkmcnt(0)
  v_lshlrev_b32 v237, 2, v237
  ds_write_b32 v237, v238 offset:256
K2_MK4:
  s_mov_b64 exec, s[52:53]
  v_cmp_eq_u32 vcc, s60, v70
  s_and_saveexec_b64 s[52:53], vcc
  s_cbranch_execz K2_MK5
  ds_add_rtn_u32 v237, v236, v239
  s_add_u32 s46, s37, 5
  s_and_b32 s46, s46, 7
  s_lshl_b32 s46, s46, 5
  v_add_u32 v238, s46, v235
  s_waitcnt lgkmcnt(0)
  v_lshlrev_b32 v237, 2, v237
  ds_write_b32 v237, v238 offset:256
K2_MK5:
  s_mov_b64 exec, s[52:53]
  v_cmp_eq_u32 vcc, s60, v72
  s_and_saveexec_b64 s[52:53], vcc
  s_cbranch_execz K2_MK6
  ds_add_rtn_u32 v237, v236, v239
  s_add_u32 s46, s37, 6
  s_and_b32 s46, s46, 7
  s_lshl_b32 s46, s46, 5
  v_add_u32 v238, s46, v235
  s_waitcnt lgkmcnt(0)
  v_lshlrev_b32 v237, 2, v237
  ds_write_b32 v237, v238 offset:256
K2_MK6:
  s_mov_b64 exec, s[52:53]
  v_cmp_eq_u32 vcc, s60, v74
  s_and_saveexec_b64 s[52:53], vcc
  s_cbranch_execz K2_MK7
  ds_add_rtn_u32 v237, v236, v239
  s_add_u32 s46, s37, 7
  s_and_b32 s46, s46, 7
  s_lshl_b32 s46, s46, 5
  v_add_u32 v238, s46, v235
  s_waitcnt lgkmcnt(0)
  v_lshlrev_b32 v237, 2, v237
  ds_write_b32 v237, v238 offset:256
K2_MK7:
  s_mov_b64 exec, s[52:53]
K2_NOMARK:
  s_load_dwordx2 s[64:65], s[0:1], 0
  s_waitcnt vmcnt(1) lgkmcnt(0)
  s_cmp_lg_u32 s32, 1
  s_cbranch_scc1 K2_NOF2B
  v_readfirstlane_b32 s98, v231
  s_mov_b32 s99, 0
  s_nop 1
K2_F2CHK:
  v_cmp_eq_u32 s[54:55], s98, v132
  v_cmp_eq_u32 vcc, s98, v133
  s_nop 1
  s_and_b64 s[54:55], s[54:55], vcc
  v_cmp_eq_u32 vcc, s98, v134
  s_nop 1
  s_and_b64 s[54:55], s[54:55], vcc
  v_cmp_eq_u32 vcc, s98, v135
  s_nop 1
  s_and_b64 s[54:55], s[54:55], vcc
  v_cmp_eq_u32 vcc, s98, v136
  s_nop 1
  s_and_b64 s[54:55], s[54:55], vcc
  v_cmp_eq_u32 vcc, s98, v137
  s_nop 1
  s_and_b64 s[54:55], s[54:55], vcc
  v_cmp_eq_u32 vcc, s98, v138
  s_nop 1
  s_and_b64 s[54:55], s[54:55], vcc
  v_cmp_eq_u32 vcc, s98, v139
  s_nop 1
  s_and_b64 s[54:55], s[54:55], vcc
  s_cmp_eq_u64 s[54:55], -1
  s_cbranch_scc1 K2_NOF2B
  s_add_u32 s99, s99, 1
  s_cmp_gt_u32 s99, 200000
  s_cbranch_scc1 K2_NOF2B
  s_mov_b32 s47, 9994240
  buffer_load_dword v132, v242, s[12:15], s47 offen offset:0 sc1
  buffer_load_dword v133, v242, s[12:15], s47 offen offset:1024 sc1
  buffer_load_dword v134, v242, s[12:15], s47 offen offset:2048 sc1
  buffer_load_dword v135, v242, s[12:15], s47 offen offset:3072 sc1
  s_mov_b32 s47, 9998336
  buffer_load_dword v136, v242, s[12:15], s47 offen offset:0 sc1
  buffer_load_dword v137, v242, s[12:15], s47 offen offset:1024 sc1
  buffer_load_dword v138, v242, s[12:15], s47 offen offset:2048 sc1
  buffer_load_dword v139, v242, s[12:15], s47 offen offset:3072 sc1
  s_waitcnt vmcnt(0)
  s_branch K2_F2CHK
K2_NOF2B:
  s_mov_b32 s68, s64
  s_and_b32 s69, s65, 0xffff
  s_mov_b32 s70, 1600000
  s_mov_b32 s71, 0x20000
  s_mov_b32 s46, 3207688728
  v_mul_f32 v243, s46, v243
  v_mul_f32 v244, s46, v244
  s_barrier
  v_mov_b32 v235, 160
  ds_read_b32 v236, v235
  ds_read_b32 v237, v234 offset:128
  ds_read_b32 v238, v212 offset:128
  s_waitcnt lgkmcnt(0)
  v_readfirstlane_b32 s56, v236
  v_min_u32 v235, 0xffffff, v237
  v_min_u32 v230, 0xffffff, v238
  s_cmp_eq_u32 s56, 0
  s_cbranch_scc1 K2_CHECK
  s_min_u32 s56, s56, 256
  s_mov_b32 s57, 0
K2_RESCAN_I:
  s_lshl_b32 s46, s57, 2
  s_add_u32 s46, s46, 256
  v_mov_b32 v235, s46
  ds_read_b32 v236, v235
  s_waitcnt lgkmcnt(0)
  v_readfirstlane_b32 s59, v236
  s_nop 3
  s_min_u32 s59, s59, 255
  s_mov_b32 s58, 0
K2_RESCAN_C:
  s_lshl_b32 s46, s58, 9
  v_add_u32 v236, s46, v0
  s_mul_i32 s47, s59, 3136
  v_add_u32 v235, s47, v236
  v_cmp_gt_u32 vcc, 3136, v236
  s_mov_b32 s46, 800000
  v_cmp_gt_u32 s[54:55], s46, v235
  s_nop 1
  s_and_b64 s[54:55], s[54:55], vcc
  v_lshlrev_b32 v236, 2, v235
  buffer_load_dword v226, v236, s[28:31], 0 offen
  buffer_load_dword v227, v236, s[24:27], 0 offen
  s_waitcnt vmcnt(0)
  v_mul_hi_u32 v237, v226, s42
  v_lshrrev_b32 v238, 3, v237
  v_cmp_eq_u32 vcc, s2, v238
  s_nop 1
  s_and_b64 vcc, vcc, s[54:55]
  s_and_saveexec_b64 s[52:53], vcc
  s_cbranch_execz K2_RA1
  v_mad_u32_u24 v238, v237, s43, v240
  v_and_b32 v237, 7, v237
  v_lshrrev_b32 v238, 9, v238
  v_lshlrev_b32 v237, 2, v237
  v_sub_u32 v238, v226, v238
  ds_add_rtn_u32 v228, v237, v239 offset:128
  v_lshl_or_b32 v235, v235, 5, v238
  s_waitcnt lgkmcnt(0)
  v_min_u32 v228, 703, v228
  v_mad_u32_u24 v228, v237, s61, v228
  v_mov_b32 v237, 77056
  v_mov_b32 v238, 99584
  v_lshl_add_u32 v237, v228, 2, v237
  v_lshl_add_u32 v238, v228, 1, v238
  ds_write_b32 v237, v235
  ds_write_b16 v238, v227
K2_RA1:
  s_mov_b64 exec, s[52:53]
  s_add_u32 s58, s58, 1
  s_cmp_lt_u32 s58, 7
  s_cbranch_scc1 K2_RESCAN_C
  s_add_u32 s57, s57, 1
  s_cmp_lt_u32 s57, s56
  s_cbranch_scc1 K2_RESCAN_I
  s_waitcnt lgkmcnt(0)
  s_barrier
  ds_read_b32 v237, v234 offset:128
  ds_read_b32 v238, v212 offset:128
  s_waitcnt lgkmcnt(0)
  v_min_u32 v235, 0xffffff, v237
  v_min_u32 v230, 0xffffff, v238
K2_CHECK:
  v_lshl_or_b32 v235, v235, 3, v232
  v_lshl_or_b32 v230, v230, 3, v233
  v_cmp_lt_u32 s[54:55], s44, v238
  v_cmp_gt_u32 vcc, v230, v235
  s_mov_b32 s96, 0
  s_nop 2
  s_bfe_u32 s46, vcc_lo, 524288
  s_bcnt1_i32_b32 s46, s46
  s_cmp_eq_u32 s46, s97
  s_cselect_b32 s96, 0, s96
  s_bfe_u32 s46, vcc_lo, 524296
  s_bcnt1_i32_b32 s46, s46
  s_cmp_eq_u32 s46, s97
  s_cselect_b32 s96, 1, s96
  s_bfe_u32 s46, vcc_lo, 524304
  s_bcnt1_i32_b32 s46, s46
  s_cmp_eq_u32 s46, s97
  s_cselect_b32 s96, 2, s96
  s_bfe_u32 s46, vcc_lo, 524312
  s_bcnt1_i32_b32 s46, s46
  s_cmp_eq_u32 s46, s97
  s_cselect_b32 s96, 3, s96
  s_bfe_u32 s46, vcc_hi, 524288
  s_bcnt1_i32_b32 s46, s46
  s_cmp_eq_u32 s46, s97
  s_cselect_b32 s96, 4, s96
  s_bfe_u32 s46, vcc_hi, 524296
  s_bcnt1_i32_b32 s46, s46
  s_cmp_eq_u32 s46, s97
  s_cselect_b32 s96, 5, s96
  s_bfe_u32 s46, vcc_hi, 524304
  s_bcnt1_i32_b32 s46, s46
  s_cmp_eq_u32 s46, s97
  s_cselect_b32 s96, 6, s96
  s_bfe_u32 s46, vcc_hi, 524312
  s_bcnt1_i32_b32 s46, s46
  s_cmp_eq_u32 s46, s97
  s_cselect_b32 s96, 7, s96
  s_lshl_b32 s46, s96, 3
  v_readlane_b32 s45, v237, s46
  s_lshl_b32 s46, s2, 3
  s_add_u32 s46, s46, s96
  s_mul_i32 s33, s46, 3125
  s_add_u32 s34, s33, 3636
  s_add_u32 s33, s33, 511
  s_lshr_b32 s33, s33, 9
  s_lshr_b32 s34, s34, 9
  s_sub_u32 s34, s34, s33
  s_mul_i32 s35, s33, 6
  s_lshl_b32 s46, s96, 11
  v_add_u32 v197, s46, v197
  v_add_u32 v196, s46, v196
  s_add_u32 s46, s46, 110848
  v_lshl_add_u32 v235, v1, 5, s46
  ds_read_b128 v[12:15], v235
  ds_read_b128 v[16:19], v235 offset:16
  v_mov_b32 v132, 0
  v_mov_b32 v133, 0
  v_mov_b32 v134, 0
  v_mov_b32 v135, 0
  ds_write_b128 v235, v[132:135]
  ds_write_b128 v235, v[132:135] offset:16
  s_cmp_eq_u64 s[54:55], 0
  s_cbranch_scc1 K2_MAIN
  s_mov_b32 s38, 1
K2_GEN:
  s_barrier
  s_cmp_lg_u32 s32, 0
  s_cbranch_scc1 K2_GEN1
  v_and_b32 v235, 7, v1
  v_lshlrev_b32 v235, 2, v235
  ds_write_b32 v235, v200 offset:128
  s_waitcnt lgkmcnt(0)
K2_GEN1:
  s_barrier
  s_lshl_b32 s46, s39, 9
  v_add_u32 v235, s46, v0
  s_mov_b32 s46, 800000
  v_cmp_gt_u32 s[54:55], s46, v235
  s_nop 1
  v_lshlrev_b32 v236, 2, v235
  buffer_load_dword v226, v236, s[28:31], 0 offen
  buffer_load_dword v227, v236, s[24:27], 0 offen
  s_waitcnt vmcnt(0)
  v_mul_hi_u32 v237, v226, s42
  v_lshrrev_b32 v238, 3, v237
  v_cmp_eq_u32 vcc, s2, v238
  s_nop 1
  s_and_b64 vcc, vcc, s[54:55]
  s_and_saveexec_b64 s[52:53], vcc
  s_cbranch_execz K2_RA2
  v_mad_u32_u24 v238, v237, s43, v240
  v_and_b32 v237, 7, v237
  v_lshrrev_b32 v238, 9, v238
  v_lshlrev_b32 v237, 2, v237
  v_sub_u32 v238, v226, v238
  ds_add_rtn_u32 v228, v237, v239 offset:128
  v_lshl_or_b32 v235, v235, 5, v238
  s_waitcnt lgkmcnt(0)
  v_min_u32 v228, 703, v228
  v_mad_u32_u24 v228, v237, s61, v228
  v_mov_b32 v237, 77056
  v_mov_b32 v238, 99584
  v_lshl_add_u32 v237, v228, 2, v237
  v_lshl_add_u32 v238, v228, 1, v238
  ds_write_b32 v237, v235
  ds_write_b16 v238, v227
K2_RA2:
  s_mov_b64 exec, s[52:53]
  s_waitcnt lgkmcnt(0)
  s_barrier
  s_lshl_b32 s46, s96, 2
  v_mov_b32 v235, s46
  ds_read_b32 v236, v235 offset:128
  s_waitcnt lgkmcnt(0)
  v_readfirstlane_b32 s45, v236
  s_nop 3
K2_MAIN:
  s_min_u32 s45, s45, 576
  s_add_u32 s36, s45, 31
  s_lshr_b32 s36, s36, 5
  s_cmp_eq_u32 s36, 0
  s_cbranch_scc1 K2_MAIN_DONE
  s_mul_i32 s46, s96, 2816
  s_add_u32 s46, s46, 77056
  s_mul_i32 s47, s96, 1408
  s_add_u32 s47, s47, 99584
  v_and_b32 v235, 31, v1
  v_lshl_add_u32 v202, v235, 2, s46
  v_lshl_add_u32 v203, v235, 1, s47
  v_lshrrev_b32 v235, 3, v1
  v_lshl_add_u32 v204, v235, 3, s47
  s_cmp_ge_u32 s45, 96
  s_cbranch_scc1 K2_FILL_BIG
  v_add_u32 v235, s45, v1
  v_lshl_add_u32 v236, v235, 2, s46
  v_lshl_add_u32 v237, v235, 1, s47
  v_mov_b32 v230, 7
  ds_write_b32 v236, v230
  ds_write_b16 v237, v200
  ds_write_b32 v236, v230 offset:256
  ds_write_b16 v237, v200 offset:128
  ds_read_b32 v238, v202
  ds_read_b64 v[210:211], v204
  ds_read_b32 v206, v202 offset:128
  ds_read_b32 v205, v202 offset:256
  ds_read_u16 v212, v203
  s_waitcnt lgkmcnt(0)
  s_branch K2_FILL
K2_FILL_BIG:
  ds_read_b32 v238, v202
  ds_read_b64 v[210:211], v204
  ds_read_b32 v206, v202 offset:128
  ds_read_b32 v205, v202 offset:256
  ds_read_u16 v212, v203
  v_add_u32 v235, s45, v1
  v_lshl_add_u32 v236, v235, 2, s46
  v_lshl_add_u32 v237, v235, 1, s47
  v_mov_b32 v230, 7
  ds_write_b32 v236, v230
  ds_write_b16 v237, v200
  ds_write_b32 v236, v230 offset:256
  ds_write_b16 v237, v200 offset:128
  s_waitcnt lgkmcnt(4)
K2_FILL:
  s_cmp_ge_u32 s32, 4
  s_cbranch_scc1 K2_FILL_B
  v_and_or_b32 v231, v238, s40, v198
  buffer_load_dwordx4 v[140:143], v231, s[8:11], 0 offen
  v_mad_u32_u16 v226, v210, s41, v192
  v_mad_u32_u16 v227, v210, s41, v193 op_sel:[1,0,0,0]
  v_mad_u32_u16 v228, v211, s41, v194
  v_mad_u32_u16 v229, v211, s41, v195 op_sel:[1,0,0,0]
  s_mov_b32 m0, s48
  s_nop 0
  buffer_load_dwordx4 v226, s[4:7], 0 offen sc1 lds
  s_mov_b32 m0, s49
  s_nop 0
  buffer_load_dwordx4 v227, s[4:7], 0 offen sc1 lds
  s_mov_b32 m0, s50
  s_nop 0
  buffer_load_dwordx4 v228, s[4:7], 0 offen sc1 lds
  s_mov_b32 m0, s51
  s_nop 0
  buffer_load_dwordx4 v229, s[4:7], 0 offen sc1 lds
  v_and_or_b32 v231, v206, s40, v198
  buffer_load_dwordx4 v[144:147], v231, s[8:11], 0 offen
  v_and_b32 v230, 7, v238
  v_mul_u32_u24 v232, 6, v212
  v_mad_u32_u24 v233, v230, 6, s35
  v_lshlrev_b32 v234, 4, v230
  v_lshl_add_u32 v207, v230, 3, v197
  ds_read_u16_d16_hi v213, v232 offset:1280
  ds_read_u16_d16_hi v214, v232 offset:1282
  ds_read_u16_d16_hi v215, v232 offset:1284
  ds_read_u16_d16_hi v216, v233 offset:1280
  ds_read_u16_d16_hi v217, v233 offset:1282
  ds_read_u16_d16_hi v218, v233 offset:1284
  ds_read_b128 v[148:151], v234 offset:0
  ds_read_b64 v[210:211], v204 offset:64
  ds_read_u16 v212, v203 offset:64
  v_mov_b32 v108, 0
  v_mov_b32 v109, 0
  v_mov_b32 v110, 0
  v_mov_b32 v111, 0
  v_mov_b32 v112, 0
  v_mov_b32 v113, 0
  v_mov_b32 v114, 0
  v_mov_b32 v115, 0
  v_mov_b32 v116, 0
  v_mov_b32 v117, 0
  v_mov_b32 v118, 0
  v_mov_b32 v119, 0
  v_mov_b32 v120, 0
  v_mov_b32 v121, 0
  v_mov_b32 v122, 0
  v_mov_b32 v123, 0
  v_mov_b32 v132, 0
  v_mov_b32 v133, 0
  v_mov_b32 v134, 0
  v_mov_b32 v135, 0
  v_mov_b32 v136, 0
  v_mov_b32 v137, 0
  v_mov_b32 v138, 0
  v_mov_b32 v139, 0
  s_waitcnt lgkmcnt(0)
  v_sub_f32 v222, v216, v213
  v_sub_f32 v223, v217, v214
  v_sub_f32 v224, v218, v215
  v_mul_f32 v225, v222, v222
  v_fmac_f32 v225, v223, v223
  v_fmac_f32 v225, v224, v224
  v_cvt_pk_bf16_f32 v220, 1.0, v222
  v_cvt_pk_bf16_f32 v221, v223, v224
  v_cvt_pk_bf16_f32 v151, v151, v225
  ds_write_b64 v207, v[220:221]
  s_branch K2_FILL_J
K2_FILL_B:
  v_and_b32 v230, 7, v238
  v_mul_u32_u24 v232, 6, v212
  v_mad_u32_u24 v233, v230, 6, s35
  v_lshlrev_b32 v234, 4, v230
  v_lshl_add_u32 v207, v230, 3, v197
  ds_read_u16_d16_hi v213, v232 offset:1280
  ds_read_u16_d16_hi v214, v232 offset:1282
  ds_read_u16_d16_hi v215, v232 offset:1284
  ds_read_u16_d16_hi v216, v233 offset:1280
  ds_read_u16_d16_hi v217, v233 offset:1282
  ds_read_u16_d16_hi v218, v233 offset:1284
  ds_read_b128 v[148:151], v234 offset:0
  ds_read_u16 v212, v203 offset:64
  v_mov_b32 v108, 0
  v_mov_b32 v109, 0
  v_mov_b32 v110, 0
  v_mov_b32 v111, 0
  v_mov_b32 v112, 0
  v_mov_b32 v113, 0
  v_mov_b32 v114, 0
  v_mov_b32 v115, 0
  v_mov_b32 v116, 0
  v_mov_b32 v117, 0
  v_mov_b32 v118, 0
  v_mov_b32 v119, 0
  v_mov_b32 v120, 0
  v_mov_b32 v121, 0
  v_mov_b32 v122, 0
  v_mov_b32 v123, 0
  v_mov_b32 v132, 0
  v_mov_b32 v133, 0
  v_mov_b32 v134, 0
  v_mov_b32 v135, 0
  v_mov_b32 v136, 0
  v_mov_b32 v137, 0
  v_mov_b32 v138, 0
  v_mov_b32 v139, 0
  s_waitcnt lgkmcnt(0)
  v_sub_f32 v222, v216, v213
  v_sub_f32 v223, v217, v214
  v_sub_f32 v224, v218, v215
  v_mul_f32 v225, v222, v222
  v_fmac_f32 v225, v223, v223
  v_fmac_f32 v225, v224, v224
  v_cvt_pk_bf16_f32 v220, 1.0, v222
  v_cvt_pk_bf16_f32 v221, v223, v224
  v_cvt_pk_bf16_f32 v151, v151, v225
  ds_write_b64 v207, v[220:221]
  v_and_or_b32 v231, v238, s40, v198
  buffer_load_dwordx4 v[140:143], v231, s[8:11], 0 offen
  v_mad_u32_u16 v226, v210, s41, v192
  v_mad_u32_u16 v227, v210, s41, v193 op_sel:[1,0,0,0]
  v_mad_u32_u16 v228, v211, s41, v194
  v_mad_u32_u16 v229, v211, s41, v195 op_sel:[1,0,0,0]
  s_mov_b32 m0, s48
  s_nop 0
  buffer_load_dwordx4 v226, s[4:7], 0 offen sc1 lds
  s_mov_b32 m0, s49
  s_nop 0
  buffer_load_dwordx4 v227, s[4:7], 0 offen sc1 lds
  s_mov_b32 m0, s50
  s_nop 0
  buffer_load_dwordx4 v228, s[4:7], 0 offen sc1 lds
  s_mov_b32 m0, s51
  s_nop 0
  buffer_load_dwordx4 v229, s[4:7], 0 offen sc1 lds
  v_and_or_b32 v231, v206, s40, v198
  buffer_load_dwordx4 v[144:147], v231, s[8:11], 0 offen
  ds_read_b64 v[210:211], v204 offset:64
  s_waitcnt lgkmcnt(0)
K2_FILL_J:
  v_mad_u32_u16 v226, v210, s41, v192
  v_mad_u32_u16 v227, v210, s41, v193 op_sel:[1,0,0,0]
  v_mad_u32_u16 v228, v211, s41, v194
  v_mad_u32_u16 v229, v211, s41, v195 op_sel:[1,0,0,0]
  v_and_b32 v230, 7, v206
  v_mul_u32_u24 v232, 6, v212
  v_mad_u32_u24 v233, v230, 6, s35
  v_lshlrev_b32 v234, 4, v230
  v_lshl_add_u32 v208, v230, 3, v197
  v_and_or_b32 v231, v205, s40, v198
  s_waitcnt vmcnt(1)
  ds_read_b128 v[92:95], v188
  ds_read_b128 v[96:99], v189
  ds_read_b128 v[100:103], v190
  ds_read_b128 v[104:107], v191
  v_mfma_f32_32x32x16_bf16 v[60:75], v[148:151], v[12:15], 0
  v_mfma_f32_32x32x16_bf16 v[60:75], v[140:143], v[4:7], v[60:75]
  s_waitcnt lgkmcnt(0)
  s_mov_b32 m0, s48
  s_nop 0
  buffer_load_dwordx4 v226, s[4:7], 0 offen sc1 lds
  s_mov_b32 m0, s49
  s_nop 0
  buffer_load_dwordx4 v227, s[4:7], 0 offen sc1 lds
  s_mov_b32 m0, s50
  s_nop 0
  buffer_load_dwordx4 v228, s[4:7], 0 offen sc1 lds
  s_mov_b32 m0, s51
  s_nop 0
  buffer_load_dwordx4 v229, s[4:7], 0 offen sc1 lds
  v_mfma_f32_32x32x16_bf16 v[60:75], v[92:95], v[20:23], v[60:75]
  v_mfma_f32_32x32x16_bf16 v[60:75], v[96:99], v[24:27], v[60:75]
  s_mov_b32 s37, 0
  s_nop 11
  .p2align 6
K2_LOOP:
  s_setprio 1
  v_mfma_f32_32x32x16_bf16 v[76:91], v[148:151], v[16:19], 0
  v_cvt_pk_bf16_f32 v124, v108, v109
  v_cvt_pk_bf16_f32 v125, v110, v111
  v_cvt_pk_bf16_f32 v126, v112, v113
  v_cvt_pk_bf16_f32 v127, v114, v115
  v_cvt_pk_bf16_f32 v128, v116, v117
  v_cvt_pk_bf16_f32 v129, v118, v119
  v_cvt_pk_bf16_f32 v130, v120, v121
  v_cvt_pk_bf16_f32 v131, v122, v123
  v_mfma_f32_32x32x16_bf16 v[76:91], v[140:143], v[8:11], v[76:91]
  v_exp_f32 v108, v60
  v_exp_f32 v109, v61
  v_exp_f32 v110, v62
  v_exp_f32 v111, v63
  v_exp_f32 v112, v64
  v_exp_f32 v113, v65
  v_mfma_f32_32x32x16_bf16 v[44:59], v[132:135], v[124:127], v[44:59]
  v_exp_f32 v114, v66
  v_exp_f32 v115, v67
  v_exp_f32 v116, v68
  v_exp_f32 v117, v69
  v_exp_f32 v118, v70
  v_exp_f32 v119, v71
  v_exp_f32 v120, v72
  v_exp_f32 v121, v73
  v_exp_f32 v122, v74
  v_exp_f32 v123, v75
  s_nop 1
  v_mfma_f32_32x32x16_bf16 v[108:123], v[184:187], v[184:187], v[108:123]
  s_setprio 0
  buffer_load_dwordx4 v[140:143], v231, s[8:11], 0 offen
  ds_read_u16_d16_hi v213, v232 offset:1280
  ds_read_u16_d16_hi v214, v232 offset:1282
  ds_read_u16_d16_hi v215, v232 offset:1284
  ds_read_u16_d16_hi v216, v233 offset:1280
  ds_read_u16_d16_hi v217, v233 offset:1282
  ds_read_u16_d16_hi v218, v233 offset:1284
  ds_read_b128 v[148:151], v234 offset:0
  ds_read_b64 v[210:211], v204 offset:128
  s_nop 1
  s_setprio 1
  v_mfma_f32_32x32x16_bf16 v[76:91], v[100:103], v[20:23], v[76:91]
  v_rcp_f32 v108, v108
  v_rcp_f32 v109, v109
  v_rcp_f32 v110, v110
  v_rcp_f32 v111, v111
  v_rcp_f32 v112, v112
  v_mfma_f32_32x32x16_bf16 v[76:91], v[104:107], v[24:27], v[76:91]
  v_rcp_f32 v113, v113
  v_rcp_f32 v114, v114
  v_rcp_f32 v115, v115
  v_rcp_f32 v116, v116
  v_rcp_f32 v117, v117
  v_mfma_f32_32x32x16_bf16 v[44:59], v[136:139], v[128:131], v[44:59]
  v_rcp_f32 v118, v118
  v_rcp_f32 v119, v119
  v_rcp_f32 v120, v120
  v_rcp_f32 v121, v121
  v_rcp_f32 v122, v122
  v_rcp_f32 v123, v123
  s_setprio 0
  v_mul_f32 v108, v60, v108
  v_mul_f32 v109, v61, v109
  v_mul_f32 v110, v62, v110
  v_mul_f32 v111, v63, v111
  v_mul_f32 v112, v64, v112
  v_mul_f32 v113, v65, v113
  v_mul_f32 v114, v66, v114
  v_mul_f32 v115, v67, v115
  v_mul_f32 v116, v68, v116
  v_mul_f32 v117, v69, v117
  v_mul_f32 v118, v70, v118
  v_mul_f32 v119, v71, v119
  v_mul_f32 v120, v72, v120
  v_mul_f32 v121, v73, v121
  v_mul_f32 v122, v74, v122
  v_mul_f32 v123, v75, v123
  s_waitcnt vmcnt(1) lgkmcnt(0)
  ds_read_b128 v[92:95], v188
  ds_read_b128 v[96:99], v189
  ds_read_b128 v[100:103], v190
  ds_read_b128 v[104:107], v191
  ds_read_b64_tr_b16 v[132:133], v196 offset:0
  ds_read_b64_tr_b16 v[134:135], v196 offset:512
  ds_read_b64_tr_b16 v[136:137], v196 offset:1024
  ds_read_b64_tr_b16 v[138:139], v196 offset:1536
  ds_write_b64 v207, v[200:201]
  v_sub_f32 v222, v216, v213
  v_sub_f32 v223, v217, v214
  v_sub_f32 v224, v218, v215
  v_mul_f32 v225, v222, v222
  v_fmac_f32 v225, v223, v223
  v_fmac_f32 v225, v224, v224
  v_mad_u32_u16 v226, v210, s41, v192
  v_mad_u32_u16 v227, v210, s41, v193 op_sel:[1,0,0,0]
  v_mad_u32_u16 v228, v211, s41, v194
  v_mad_u32_u16 v229, v211, s41, v195 op_sel:[1,0,0,0]
  v_cvt_pk_bf16_f32 v220, 1.0, v222
  v_cvt_pk_bf16_f32 v221, v223, v224
  v_cvt_pk_bf16_f32 v151, v151, v225
  ds_write_b64 v208, v[220:221]
  s_nop 0
  s_setprio 1
  v_mfma_f32_32x32x16_bf16 v[60:75], v[148:151], v[12:15], 0
  v_cvt_pk_bf16_f32 v124, v108, v109
  v_cvt_pk_bf16_f32 v125, v110, v111
  v_cvt_pk_bf16_f32 v126, v112, v113
  v_cvt_pk_bf16_f32 v127, v114, v115
  v_cvt_pk_bf16_f32 v128, v116, v117
  v_cvt_pk_bf16_f32 v129, v118, v119
  v_cvt_pk_bf16_f32 v130, v120, v121
  v_cvt_pk_bf16_f32 v131, v122, v123
  v_mfma_f32_32x32x16_bf16 v[60:75], v[144:147], v[4:7], v[60:75]
  v_exp_f32 v108, v76
  v_exp_f32 v109, v77
  v_exp_f32 v110, v78
  v_exp_f32 v111, v79
  v_exp_f32 v112, v80
  v_exp_f32 v113, v81
  s_waitcnt lgkmcnt(2)
  v_mfma_f32_32x32x16_bf16 v[28:43], v[132:135], v[124:127], v[28:43]
  v_exp_f32 v114, v82
  v_exp_f32 v115, v83
  v_exp_f32 v116, v84
  v_exp_f32 v117, v85
  v_exp_f32 v118, v86
  v_exp_f32 v119, v87
  v_exp_f32 v120, v88
  v_exp_f32 v121, v89
  v_exp_f32 v122, v90
  v_exp_f32 v123, v91
  s_nop 1
  v_mfma_f32_32x32x16_bf16 v[108:123], v[184:187], v[184:187], v[108:123]
  s_setprio 0
  s_waitcnt lgkmcnt(0)
  s_mov_b32 m0, s48
  s_nop 0
  buffer_load_dwordx4 v226, s[4:7], 0 offen sc1 lds
  s_mov_b32 m0, s49
  s_nop 0
  buffer_load_dwordx4 v227, s[4:7], 0 offen sc1 lds
  s_mov_b32 m0, s50
  s_nop 0
  buffer_load_dwordx4 v228, s[4:7], 0 offen sc1 lds
  s_mov_b32 m0, s51
  s_nop 0
  buffer_load_dwordx4 v229, s[4:7], 0 offen sc1 lds
  ds_read_b32 v206, v202 offset:384
  ds_read_u16 v212, v203 offset:128
  s_setprio 1
  v_mfma_f32_32x32x16_bf16 v[60:75], v[92:95], v[20:23], v[60:75]
  v_rcp_f32 v108, v108
  v_rcp_f32 v109, v109
  v_rcp_f32 v110, v110
  v_rcp_f32 v111, v111
  v_rcp_f32 v112, v112
  v_mfma_f32_32x32x16_bf16 v[60:75], v[96:99], v[24:27], v[60:75]
  v_rcp_f32 v113, v113
  v_rcp_f32 v114, v114
  v_rcp_f32 v115, v115
  v_rcp_f32 v116, v116
  v_rcp_f32 v117, v117
  v_mfma_f32_32x32x16_bf16 v[28:43], v[136:139], v[128:131], v[28:43]
  v_rcp_f32 v118, v118
  v_rcp_f32 v119, v119
  v_rcp_f32 v120, v120
  v_rcp_f32 v121, v121
  v_rcp_f32 v122, v122
  v_rcp_f32 v123, v123
  s_setprio 0
  v_mul_f32 v108, v76, v108
  v_mul_f32 v109, v77, v109
  v_mul_f32 v110, v78, v110
  v_mul_f32 v111, v79, v111
  v_mul_f32 v112, v80, v112
  v_mul_f32 v113, v81, v113
  v_mul_f32 v114, v82, v114
  v_mul_f32 v115, v83, v115
  v_mul_f32 v116, v84, v116
  v_mul_f32 v117, v85, v117
  v_mul_f32 v118, v86, v118
  v_mul_f32 v119, v87, v119
  v_mul_f32 v120, v88, v120
  v_mul_f32 v121, v89, v121
  v_mul_f32 v122, v90, v122
  v_mul_f32 v123, v91, v123
  s_waitcnt lgkmcnt(0)
  v_and_or_b32 v231, v206, s40, v198
  v_and_b32 v230, 7, v205
  v_mul_u32_u24 v232, 6, v212
  v_mad_u32_u24 v233, v230, 6, s35
  v_lshlrev_b32 v234, 4, v230
  v_lshl_add_u32 v207, v230, 3, v197
  s_add_u32 s37, s37, 1
  s_cmp_ge_u32 s37, s36
  s_cbranch_scc1 K2_EXIT_ODD
  s_setprio 1
  v_mfma_f32_32x32x16_bf16 v[76:91], v[148:151], v[16:19], 0
  v_cvt_pk_bf16_f32 v124, v108, v109
  v_cvt_pk_bf16_f32 v125, v110, v111
  v_cvt_pk_bf16_f32 v126, v112, v113
  v_cvt_pk_bf16_f32 v127, v114, v115
  v_cvt_pk_bf16_f32 v128, v116, v117
  v_cvt_pk_bf16_f32 v129, v118, v119
  v_cvt_pk_bf16_f32 v130, v120, v121
  v_cvt_pk_bf16_f32 v131, v122, v123
  v_mfma_f32_32x32x16_bf16 v[76:91], v[144:147], v[8:11], v[76:91]
  v_exp_f32 v108, v60
  v_exp_f32 v109, v61
  v_exp_f32 v110, v62
  v_exp_f32 v111, v63
  v_exp_f32 v112, v64
  v_exp_f32 v113, v65
  v_mfma_f32_32x32x16_bf16 v[44:59], v[132:135], v[124:127], v[44:59]
  v_exp_f32 v114, v66
  v_exp_f32 v115, v67
  v_exp_f32 v116, v68
  v_exp_f32 v117, v69
  v_exp_f32 v118, v70
  v_exp_f32 v119, v71
  v_exp_f32 v120, v72
  v_exp_f32 v121, v73
  v_exp_f32 v122, v74
  v_exp_f32 v123, v75
  s_nop 1
  v_mfma_f32_32x32x16_bf16 v[108:123], v[184:187], v[184:187], v[108:123]
  s_setprio 0
  buffer_load_dwordx4 v[144:147], v231, s[8:11], 0 offen
  ds_read_u16_d16_hi v213, v232 offset:1280
  ds_read_u16_d16_hi v214, v232 offset:1282
  ds_read_u16_d16_hi v215, v232 offset:1284
  ds_read_u16_d16_hi v216, v233 offset:1280
  ds_read_u16_d16_hi v217, v233 offset:1282
  ds_read_u16_d16_hi v218, v233 offset:1284
  ds_read_b128 v[148:151], v234 offset:0
  ds_read_b64 v[210:211], v204 offset:192
  s_nop 1
  s_setprio 1
  v_mfma_f32_32x32x16_bf16 v[76:91], v[100:103], v[20:23], v[76:91]
  v_rcp_f32 v108, v108
  v_rcp_f32 v109, v109
  v_rcp_f32 v110, v110
  v_rcp_f32 v111, v111
  v_rcp_f32 v112, v112
  v_mfma_f32_32x32x16_bf16 v[76:91], v[104:107], v[24:27], v[76:91]
  v_rcp_f32 v113, v113
  v_rcp_f32 v114, v114
  v_rcp_f32 v115, v115
  v_rcp_f32 v116, v116
  v_rcp_f32 v117, v117
  v_mfma_f32_32x32x16_bf16 v[44:59], v[136:139], v[128:131], v[44:59]
  v_rcp_f32 v118, v118
  v_rcp_f32 v119, v119
  v_rcp_f32 v120, v120
  v_rcp_f32 v121, v121
  v_rcp_f32 v122, v122
  v_rcp_f32 v123, v123
  s_setprio 0
  v_mul_f32 v108, v60, v108
  v_mul_f32 v109, v61, v109
  v_mul_f32 v110, v62, v110
  v_mul_f32 v111, v63, v111
  v_mul_f32 v112, v64, v112
  v_mul_f32 v113, v65, v113
  v_mul_f32 v114, v66, v114
  v_mul_f32 v115, v67, v115
  v_mul_f32 v116, v68, v116
  v_mul_f32 v117, v69, v117
  v_mul_f32 v118, v70, v118
  v_mul_f32 v119, v71, v119
  v_mul_f32 v120, v72, v120
  v_mul_f32 v121, v73, v121
  v_mul_f32 v122, v74, v122
  v_mul_f32 v123, v75, v123
  s_waitcnt vmcnt(1) lgkmcnt(0)
  ds_read_b128 v[92:95], v188
  ds_read_b128 v[96:99], v189
  ds_read_b128 v[100:103], v190
  ds_read_b128 v[104:107], v191
  ds_read_b64_tr_b16 v[132:133], v196 offset:0
  ds_read_b64_tr_b16 v[134:135], v196 offset:512
  ds_read_b64_tr_b16 v[136:137], v196 offset:1024
  ds_read_b64_tr_b16 v[138:139], v196 offset:1536
  ds_write_b64 v208, v[200:201]
  v_sub_f32 v222, v216, v213
  v_sub_f32 v223, v217, v214
  v_sub_f32 v224, v218, v215
  v_mul_f32 v225, v222, v222
  v_fmac_f32 v225, v223, v223
  v_fmac_f32 v225, v224, v224
  v_mad_u32_u16 v226, v210, s41, v192
  v_mad_u32_u16 v227, v210, s41, v193 op_sel:[1,0,0,0]
  v_mad_u32_u16 v228, v211, s41, v194
  v_mad_u32_u16 v229, v211, s41, v195 op_sel:[1,0,0,0]
  v_cvt_pk_bf16_f32 v220, 1.0, v222
  v_cvt_pk_bf16_f32 v221, v223, v224
  v_cvt_pk_bf16_f32 v151, v151, v225
  ds_write_b64 v207, v[220:221]
  s_nop 0
  s_setprio 1
  v_mfma_f32_32x32x16_bf16 v[60:75], v[148:151], v[12:15], 0
  v_cvt_pk_bf16_f32 v124, v108, v109
  v_cvt_pk_bf16_f32 v125, v110, v111
  v_cvt_pk_bf16_f32 v126, v112, v113
  v_cvt_pk_bf16_f32 v127, v114, v115
  v_cvt_pk_bf16_f32 v128, v116, v117
  v_cvt_pk_bf16_f32 v129, v118, v119
  v_cvt_pk_bf16_f32 v130, v120, v121
  v_cvt_pk_bf16_f32 v131, v122, v123
  v_mfma_f32_32x32x16_bf16 v[60:75], v[140:143], v[4:7], v[60:75]
  v_exp_f32 v108, v76
  v_exp_f32 v109, v77
  v_exp_f32 v110, v78
  v_exp_f32 v111, v79
  v_exp_f32 v112, v80
  v_exp_f32 v113, v81
  s_waitcnt lgkmcnt(2)
  v_mfma_f32_32x32x16_bf16 v[28:43], v[132:135], v[124:127], v[28:43]
  v_exp_f32 v114, v82
  v_exp_f32 v115, v83
  v_exp_f32 v116, v84
  v_exp_f32 v117, v85
  v_exp_f32 v118, v86
  v_exp_f32 v119, v87
  v_exp_f32 v120, v88
  v_exp_f32 v121, v89
  v_exp_f32 v122, v90
  v_exp_f32 v123, v91
  s_nop 1
  v_mfma_f32_32x32x16_bf16 v[108:123], v[184:187], v[184:187], v[108:123]
  s_setprio 0
  s_waitcnt lgkmcnt(0)
  s_mov_b32 m0, s48
  s_nop 0
  buffer_load_dwordx4 v226, s[4:7], 0 offen sc1 lds
  s_mov_b32 m0, s49
  s_nop 0
  buffer_load_dwordx4 v227, s[4:7], 0 offen sc1 lds
  s_mov_b32 m0, s50
  s_nop 0
  buffer_load_dwordx4 v228, s[4:7], 0 offen sc1 lds
  s_mov_b32 m0, s51
  s_nop 0
  buffer_load_dwordx4 v229, s[4:7], 0 offen sc1 lds
  ds_read_b32 v205, v202 offset:512
  ds_read_u16 v212, v203 offset:192
  s_setprio 1
  v_mfma_f32_32x32x16_bf16 v[60:75], v[92:95], v[20:23], v[60:75]
  v_rcp_f32 v108, v108
  v_rcp_f32 v109, v109
  v_rcp_f32 v110, v110
  v_rcp_f32 v111, v111
  v_rcp_f32 v112, v112
  v_mfma_f32_32x32x16_bf16 v[60:75], v[96:99], v[24:27], v[60:75]
  v_rcp_f32 v113, v113
  v_rcp_f32 v114, v114
  v_rcp_f32 v115, v115
  v_rcp_f32 v116, v116
  v_rcp_f32 v117, v117
  v_mfma_f32_32x32x16_bf16 v[28:43], v[136:139], v[128:131], v[28:43]
  v_rcp_f32 v118, v118
  v_rcp_f32 v119, v119
  v_rcp_f32 v120, v120
  v_rcp_f32 v121, v121
  v_rcp_f32 v122, v122
  v_rcp_f32 v123, v123
  s_setprio 0
  v_mul_f32 v108, v76, v108
  v_mul_f32 v109, v77, v109
  v_mul_f32 v110, v78, v110
  v_mul_f32 v111, v79, v111
  v_mul_f32 v112, v80, v112
  v_mul_f32 v113, v81, v113
  v_mul_f32 v114, v82, v114
  v_mul_f32 v115, v83, v115
  v_mul_f32 v116, v84, v116
  v_mul_f32 v117, v85, v117
  v_mul_f32 v118, v86, v118
  v_mul_f32 v119, v87, v119
  v_mul_f32 v120, v88, v120
  v_mul_f32 v121, v89, v121
  v_mul_f32 v122, v90, v122
  v_mul_f32 v123, v91, v123
  s_waitcnt lgkmcnt(0)
  v_and_or_b32 v231, v205, s40, v198
  v_and_b32 v230, 7, v206
  v_mul_u32_u24 v232, 6, v212
  v_mad_u32_u24 v233, v230, 6, s35
  v_lshlrev_b32 v234, 4, v230
  v_lshl_add_u32 v208, v230, 3, v197
  v_add_u32 v202, 256, v202
  v_add_u32 v203, 128, v203
  v_add_u32 v204, 128, v204
  s_add_u32 s37, s37, 1
  s_cmp_lt_u32 s37, s36
  s_cbranch_scc1 K2_LOOP
  v_cvt_pk_bf16_f32 v124, v108, v109
  v_cvt_pk_bf16_f32 v125, v110, v111
  v_cvt_pk_bf16_f32 v126, v112, v113
  v_cvt_pk_bf16_f32 v127, v114, v115
  v_cvt_pk_bf16_f32 v128, v116, v117
  v_cvt_pk_bf16_f32 v129, v118, v119
  v_cvt_pk_bf16_f32 v130, v120, v121
  v_cvt_pk_bf16_f32 v131, v122, v123
  ds_write_b64 v207, v[200:201]
  s_nop 0
  v_mfma_f32_32x32x16_bf16 v[44:59], v[132:135], v[124:127], v[44:59]
  v_mfma_f32_32x32x16_bf16 v[44:59], v[136:139], v[128:131], v[44:59]
  s_branch K2_LOOP_DONE
K2_EXIT_ODD:
  v_cvt_pk_bf16_f32 v124, v108, v109
  v_cvt_pk_bf16_f32 v125, v110, v111
  v_cvt_pk_bf16_f32 v126, v112, v113
  v_cvt_pk_bf16_f32 v127, v114, v115
  v_cvt_pk_bf16_f32 v128, v116, v117
  v_cvt_pk_bf16_f32 v129, v118, v119
  v_cvt_pk_bf16_f32 v130, v120, v121
  v_cvt_pk_bf16_f32 v131, v122, v123
  ds_write_b64 v208, v[200:201]
  s_nop 0
  v_mfma_f32_32x32x16_bf16 v[44:59], v[132:135], v[124:127], v[44:59]
  v_mfma_f32_32x32x16_bf16 v[44:59], v[136:139], v[128:131], v[44:59]
K2_LOOP_DONE:
  s_setprio 0
K2_MAIN_DONE:
  s_cmp_eq_u32 s38, 0
  s_cbranch_scc1 K2_EPI
  s_waitcnt vmcnt(0) lgkmcnt(0)
  s_add_u32 s39, s39, 1
  s_cmp_lt_u32 s39, 1563
  s_cbranch_scc1 K2_GEN
K2_EPI:
  s_lshl_b32 s62, s96, 11
  s_add_u32 s62, s62, 110848
  v_and_b32 v230, 31, v1
  s_mov_b32 s46, 3207688728
  v_lshrrev_b32 v237, 5, v1
  v_lshlrev_b32 v237, 7, v237
  v_lshl_add_u32 v237, v230, 1, v237
  v_add_u32 v237, s62, v237
  s_nop 7
  v_mul_f32 v226, s46, v28
  v_mul_f32 v227, s46, v44
  v_cvt_pk_bf16_f32 v228, v226, v227
  ds_write_b16 v237, v228 offset:0
  ds_write_b16_d16_hi v237, v228 offset:64
  v_mul_f32 v226, s46, v32
  v_mul_f32 v227, s46, v48
  v_cvt_pk_bf16_f32 v228, v226, v227
  ds_write_b16 v237, v228 offset:256
  ds_write_b16_d16_hi v237, v228 offset:320
  v_mul_f32 v226, s46, v36
  v_mul_f32 v227, s46, v52
  v_cvt_pk_bf16_f32 v228, v226, v227
  ds_write_b16 v237, v228 offset:512
  ds_write_b16_d16_hi v237, v228 offset:576
  v_mul_f32 v226, s46, v40
  v_mul_f32 v227, s46, v56
  v_cvt_pk_bf16_f32 v228, v226, v227
  ds_write_b16 v237, v228 offset:768
  ds_write_b16_d16_hi v237, v228 offset:832
  s_cmp_lt_u32 s32, 4
  s_cbranch_scc1 K2_EPI_NOJOB
  s_sub_u32 s47, s32, 4
  s_lshr_b32 s47, s47, 1
  s_lshl_b32 s47, s47, 2
  v_bfe_u32 v235, v1, 3, 2
  v_add_u32 v235, s47, v235
  v_and_b32 v230, 7, v1
  v_lshlrev_b32 v204, 11, v235
  v_lshl_add_u32 v204, v230, 7, v204
  v_add_u32 v204, 110848, v204
  v_add_u32 v204, v204, v198
  s_lshl_b32 s47, s2, 3
  v_add_u32 v235, s47, v235
  v_mad_u32_u24 v210, v235, s43, v240
  v_add_u32 v211, 3125, v210
  v_lshrrev_b32 v210, 9, v210
  v_lshrrev_b32 v211, 9, v211
  v_sub_u32 v211, v211, v210
  v_cmp_lt_u32 vcc, v230, v211
  v_add_u32 v236, -1, v211
  v_min_u32 v236, v236, v230
  v_add_u32 v236, v210, v236
  v_lshlrev_b32 v236, 7, v236
  v_add_u32 v235, v236, v198
  buffer_load_dwordx4 v[92:95], v235, s[68:71], 0 offen offset:0
  buffer_load_dwordx4 v[96:99], v235, s[68:71], 0 offen offset:32
  buffer_load_dwordx4 v[100:103], v235, s[68:71], 0 offen offset:64
  buffer_load_dwordx4 v[104:107], v235, s[68:71], 0 offen offset:96
  s_and_b32 s47, s32, 1
  s_lshl_b32 s47, s47, 6
  v_lshrrev_b32 v235, 1, v198
  v_add3_u32 v202, v236, v235, s47
  buffer_load_dwordx2 v[124:125], v202, s[68:71], 0 offen offset:0
  buffer_load_dwordx2 v[126:127], v202, s[68:71], 0 offen offset:16
  buffer_load_dwordx2 v[128:129], v202, s[68:71], 0 offen offset:32
  buffer_load_dwordx2 v[130:131], v202, s[68:71], 0 offen offset:48
  v_mov_b32 v235, 0x40000000
  v_cndmask_b32 v203, v235, v202, vcc
  v_mul_f32 v108, v243, v29
  v_fmac_f32 v108, v244, v45
  v_mul_f32 v109, v243, v30
  v_fmac_f32 v109, v244, v46
  v_mul_f32 v110, v243, v31
  v_fmac_f32 v110, v244, v47
  v_mul_f32 v111, v243, v33
  v_fmac_f32 v111, v244, v49
  v_mul_f32 v112, v243, v34
  v_fmac_f32 v112, v244, v50
  v_mul_f32 v113, v243, v35
  v_fmac_f32 v113, v244, v51
  v_mul_f32 v114, v243, v37
  v_fmac_f32 v114, v244, v53
  v_mul_f32 v115, v243, v38
  v_fmac_f32 v115, v244, v54
  v_mul_f32 v116, v243, v39
  v_fmac_f32 v116, v244, v55
  v_mul_f32 v117, v243, v41
  v_fmac_f32 v117, v244, v57
  v_mul_f32 v118, v243, v42
  v_fmac_f32 v118, v244, v58
  v_mul_f32 v119, v243, v43
  v_fmac_f32 v119, v244, v59
  v_add_f32_dpp v108, v108, v108 row_shr:1 row_mask:0xf bank_mask:0xf bound_ctrl:0
  v_add_f32_dpp v109, v109, v109 row_shr:1 row_mask:0xf bank_mask:0xf bound_ctrl:0
  v_add_f32_dpp v110, v110, v110 row_shr:1 row_mask:0xf bank_mask:0xf bound_ctrl:0
  v_add_f32_dpp v111, v111, v111 row_shr:1 row_mask:0xf bank_mask:0xf bound_ctrl:0
  v_add_f32_dpp v112, v112, v112 row_shr:1 row_mask:0xf bank_mask:0xf bound_ctrl:0
  v_add_f32_dpp v113, v113, v113 row_shr:1 row_mask:0xf bank_mask:0xf bound_ctrl:0
  v_add_f32_dpp v114, v114, v114 row_shr:1 row_mask:0xf bank_mask:0xf bound_ctrl:0
  v_add_f32_dpp v115, v115, v115 row_shr:1 row_mask:0xf bank_mask:0xf bound_ctrl:0
  v_add_f32_dpp v116, v116, v116 row_shr:1 row_mask:0xf bank_mask:0xf bound_ctrl:0
  v_add_f32_dpp v117, v117, v117 row_shr:1 row_mask:0xf bank_mask:0xf bound_ctrl:0
  v_add_f32_dpp v118, v118, v118 row_shr:1 row_mask:0xf bank_mask:0xf bound_ctrl:0
  v_add_f32_dpp v119, v119, v119 row_shr:1 row_mask:0xf bank_mask:0xf bound_ctrl:0
  v_add_f32_dpp v108, v108, v108 row_shr:2 row_mask:0xf bank_mask:0xf bound_ctrl:0
  v_add_f32_dpp v109, v109, v109 row_shr:2 row_mask:0xf bank_mask:0xf bound_ctrl:0
  v_add_f32_dpp v110, v110, v110 row_shr:2 row_mask:0xf bank_mask:0xf bound_ctrl:0
  v_add_f32_dpp v111, v111, v111 row_shr:2 row_mask:0xf bank_mask:0xf bound_ctrl:0
  v_add_f32_dpp v112, v112, v112 row_shr:2 row_mask:0xf bank_mask:0xf bound_ctrl:0
  v_add_f32_dpp v113, v113, v113 row_shr:2 row_mask:0xf bank_mask:0xf bound_ctrl:0
  v_add_f32_dpp v114, v114, v114 row_shr:2 row_mask:0xf bank_mask:0xf bound_ctrl:0
  v_add_f32_dpp v115, v115, v115 row_shr:2 row_mask:0xf bank_mask:0xf bound_ctrl:0
  v_add_f32_dpp v116, v116, v116 row_shr:2 row_mask:0xf bank_mask:0xf bound_ctrl:0
  v_add_f32_dpp v117, v117, v117 row_shr:2 row_mask:0xf bank_mask:0xf bound_ctrl:0
  v_add_f32_dpp v118, v118, v118 row_shr:2 row_mask:0xf bank_mask:0xf bound_ctrl:0
  v_add_f32_dpp v119, v119, v119 row_shr:2 row_mask:0xf bank_mask:0xf bound_ctrl:0
  v_add_f32_dpp v108, v108, v108 row_shr:4 row_mask:0xf bank_mask:0xf bound_ctrl:0
  v_add_f32_dpp v109, v109, v109 row_shr:4 row_mask:0xf bank_mask:0xf bound_ctrl:0
  v_add_f32_dpp v110, v110, v110 row_shr:4 row_mask:0xf bank_mask:0xf bound_ctrl:0
  v_add_f32_dpp v111, v111, v111 row_shr:4 row_mask:0xf bank_mask:0xf bound_ctrl:0
  v_add_f32_dpp v112, v112, v112 row_shr:4 row_mask:0xf bank_mask:0xf bound_ctrl:0
  v_add_f32_dpp v113, v113, v113 row_shr:4 row_mask:0xf bank_mask:0xf bound_ctrl:0
  v_add_f32_dpp v114, v114, v114 row_shr:4 row_mask:0xf bank_mask:0xf bound_ctrl:0
  v_add_f32_dpp v115, v115, v115 row_shr:4 row_mask:0xf bank_mask:0xf bound_ctrl:0
  v_add_f32_dpp v116, v116, v116 row_shr:4 row_mask:0xf bank_mask:0xf bound_ctrl:0
  v_add_f32_dpp v117, v117, v117 row_shr:4 row_mask:0xf bank_mask:0xf bound_ctrl:0
  v_add_f32_dpp v118, v118, v118 row_shr:4 row_mask:0xf bank_mask:0xf bound_ctrl:0
  v_add_f32_dpp v119, v119, v119 row_shr:4 row_mask:0xf bank_mask:0xf bound_ctrl:0
  v_add_f32_dpp v108, v108, v108 row_shr:8 row_mask:0xf bank_mask:0xf bound_ctrl:0
  v_add_f32_dpp v109, v109, v109 row_shr:8 row_mask:0xf bank_mask:0xf bound_ctrl:0
  v_add_f32_dpp v110, v110, v110 row_shr:8 row_mask:0xf bank_mask:0xf bound_ctrl:0
  v_add_f32_dpp v111, v111, v111 row_shr:8 row_mask:0xf bank_mask:0xf bound_ctrl:0
  v_add_f32_dpp v112, v112, v112 row_shr:8 row_mask:0xf bank_mask:0xf bound_ctrl:0
  v_add_f32_dpp v113, v113, v113 row_shr:8 row_mask:0xf bank_mask:0xf bound_ctrl:0
  v_add_f32_dpp v114, v114, v114 row_shr:8 row_mask:0xf bank_mask:0xf bound_ctrl:0
  v_add_f32_dpp v115, v115, v115 row_shr:8 row_mask:0xf bank_mask:0xf bound_ctrl:0
  v_add_f32_dpp v116, v116, v116 row_shr:8 row_mask:0xf bank_mask:0xf bound_ctrl:0
  v_add_f32_dpp v117, v117, v117 row_shr:8 row_mask:0xf bank_mask:0xf bound_ctrl:0
  v_add_f32_dpp v118, v118, v118 row_shr:8 row_mask:0xf bank_mask:0xf bound_ctrl:0
  v_add_f32_dpp v119, v119, v119 row_shr:8 row_mask:0xf bank_mask:0xf bound_ctrl:0
  v_add_f32_dpp v108, v108, v108 row_bcast:15 row_mask:0xa bank_mask:0xf
  v_add_f32_dpp v109, v109, v109 row_bcast:15 row_mask:0xa bank_mask:0xf
  v_add_f32_dpp v110, v110, v110 row_bcast:15 row_mask:0xa bank_mask:0xf
  v_add_f32_dpp v111, v111, v111 row_bcast:15 row_mask:0xa bank_mask:0xf
  v_add_f32_dpp v112, v112, v112 row_bcast:15 row_mask:0xa bank_mask:0xf
  v_add_f32_dpp v113, v113, v113 row_bcast:15 row_mask:0xa bank_mask:0xf
  v_add_f32_dpp v114, v114, v114 row_bcast:15 row_mask:0xa bank_mask:0xf
  v_add_f32_dpp v115, v115, v115 row_bcast:15 row_mask:0xa bank_mask:0xf
  v_add_f32_dpp v116, v116, v116 row_bcast:15 row_mask:0xa bank_mask:0xf
  v_add_f32_dpp v117, v117, v117 row_bcast:15 row_mask:0xa bank_mask:0xf
  v_add_f32_dpp v118, v118, v118 row_bcast:15 row_mask:0xa bank_mask:0xf
  v_add_f32_dpp v119, v119, v119 row_bcast:15 row_mask:0xa bank_mask:0xf
  v_lshrrev_b32 v237, 5, v1
  v_lshlrev_b32 v237, 4, v237
  s_add_u32 s46, s62, 1024
  v_add_u32 v237, s46, v237
  s_mov_b32 exec_lo, 0x80000000
  s_mov_b32 exec_hi, 0x80000000
  ds_write_b32 v237, v108 offset:0
  ds_write_b32 v237, v109 offset:4
  ds_write_b32 v237, v110 offset:8
  ds_write_b32 v237, v111 offset:32
  ds_write_b32 v237, v112 offset:36
  ds_write_b32 v237, v113 offset:40
  ds_write_b32 v237, v114 offset:64
  ds_write_b32 v237, v115 offset:68
  ds_write_b32 v237, v116 offset:72
  ds_write_b32 v237, v117 offset:96
  ds_write_b32 v237, v118 offset:100
  ds_write_b32 v237, v119 offset:104
  s_mov_b64 exec, -1
  v_mul_u32_u24 v237, 86, v1
  v_lshrrev_b32 v237, 8, v237
  v_mul_u32_u24 v238, 3, v237
  v_sub_u32 v238, v1, v238
  v_lshlrev_b32 v237, 4, v237
  v_lshl_add_u32 v237, v238, 2, v237
  v_add_u32 v237, s46, v237
  v_min_u32 v237, 159996, v237
  ds_read_b32 v226, v237
  v_lshl_add_u32 v238, v1, 1, s35
  v_min_u32 v237, 75774, v238
  ds_read_u16_d16_hi v213, v237 offset:1280
  s_mul_i32 s46, s34, 3
  v_cmp_gt_u32 vcc, s46, v1
  v_add_u32 v238, 1600000, v238
  v_mov_b32 v237, 0x40000000
  s_waitcnt lgkmcnt(0)
  v_cndmask_b32 v238, v237, v238, vcc
  v_add_f32 v226, v226, v213
  v_cvt_pk_bf16_f32 v226, v226, v226
  buffer_store_short v226, v238, s[16:19], 0 offen
  s_waitcnt vmcnt(1)
  v_mfma_f32_32x32x16_bf16 v[60:75], v[152:155], v[92:95], 0
  v_mfma_f32_32x32x16_bf16 v[60:75], v[156:159], v[96:99], v[60:75]
  v_mfma_f32_32x32x16_bf16 v[60:75], v[160:163], v[100:103], v[60:75]
  v_mfma_f32_32x32x16_bf16 v[60:75], v[164:167], v[104:107], v[60:75]
  v_lshlrev_b32 v28, 16, v124
  v_and_b32 v29, 0xffff0000, v124
  v_lshlrev_b32 v30, 16, v125
  v_and_b32 v31, 0xffff0000, v125
  v_lshlrev_b32 v32, 16, v126
  v_and_b32 v33, 0xffff0000, v126
  v_lshlrev_b32 v34, 16, v127
  v_and_b32 v35, 0xffff0000, v127
  v_lshlrev_b32 v36, 16, v128
  v_and_b32 v37, 0xffff0000, v128
  v_lshlrev_b32 v38, 16, v129
  v_and_b32 v39, 0xffff0000, v129
  v_lshlrev_b32 v40, 16, v130
  v_and_b32 v41, 0xffff0000, v130
  v_lshlrev_b32 v42, 16, v131
  v_and_b32 v43, 0xffff0000, v131
  s_barrier
  ds_read_b128 v[140:143], v204 offset:0
  ds_read_b128 v[144:147], v204 offset:32
  ds_read_b128 v[132:135], v204 offset:64
  ds_read_b128 v[136:139], v204 offset:96
  s_waitcnt lgkmcnt(3)
  v_mfma_f32_32x32x16_bf16 v[60:75], v[168:171], v[140:143], v[60:75]
  s_waitcnt lgkmcnt(2)
  v_mfma_f32_32x32x16_bf16 v[60:75], v[172:175], v[144:147], v[60:75]
  s_waitcnt lgkmcnt(1)
  v_mfma_f32_32x32x16_bf16 v[60:75], v[176:179], v[132:135], v[60:75]
  s_waitcnt lgkmcnt(0)
  v_mfma_f32_32x32x16_bf16 v[60:75], v[180:183], v[136:139], v[60:75]
  s_mov_b32 s46, 3216550459
  s_nop 13
  v_mul_f32 v108, s46, v60
  v_mul_f32 v109, s46, v61
  v_mul_f32 v110, s46, v62
  v_mul_f32 v111, s46, v63
  v_mul_f32 v112, s46, v64
  v_mul_f32 v113, s46, v65
  v_mul_f32 v114, s46, v66
  v_mul_f32 v115, s46, v67
  v_mul_f32 v116, s46, v68
  v_mul_f32 v117, s46, v69
  v_mul_f32 v118, s46, v70
  v_mul_f32 v119, s46, v71
  v_mul_f32 v120, s46, v72
  v_mul_f32 v121, s46, v73
  v_mul_f32 v122, s46, v74
  v_mul_f32 v123, s46, v75
  v_exp_f32 v108, v108
  v_exp_f32 v109, v109
  v_exp_f32 v110, v110
  v_exp_f32 v111, v111
  v_exp_f32 v112, v112
  v_exp_f32 v113, v113
  v_exp_f32 v114, v114
  v_exp_f32 v115, v115
  v_exp_f32 v116, v116
  v_exp_f32 v117, v117
  v_exp_f32 v118, v118
  v_exp_f32 v119, v119
  v_exp_f32 v120, v120
  v_exp_f32 v121, v121
  v_exp_f32 v122, v122
  v_exp_f32 v123, v123
  v_add_f32 v108, 1.0, v108
  v_add_f32 v109, 1.0, v109
  v_add_f32 v110, 1.0, v110
  v_add_f32 v111, 1.0, v111
  v_add_f32 v112, 1.0, v112
  v_add_f32 v113, 1.0, v113
  v_add_f32 v114, 1.0, v114
  v_add_f32 v115, 1.0, v115
  v_add_f32 v116, 1.0, v116
  v_add_f32 v117, 1.0, v117
  v_add_f32 v118, 1.0, v118
  v_add_f32 v119, 1.0, v119
  v_add_f32 v120, 1.0, v120
  v_add_f32 v121, 1.0, v121
  v_add_f32 v122, 1.0, v122
  v_add_f32 v123, 1.0, v123
  v_rcp_f32 v108, v108
  v_rcp_f32 v109, v109
  v_rcp_f32 v110, v110
  v_rcp_f32 v111, v111
  v_rcp_f32 v112, v112
  v_rcp_f32 v113, v113
  v_rcp_f32 v114, v114
  v_rcp_f32 v115, v115
  v_rcp_f32 v116, v116
  v_rcp_f32 v117, v117
  v_rcp_f32 v118, v118
  v_rcp_f32 v119, v119
  v_rcp_f32 v120, v120
  v_rcp_f32 v121, v121
  v_rcp_f32 v122, v122
  v_rcp_f32 v123, v123
  s_nop 0
  v_fma_f32 v108, v60, v108, v28
  v_fma_f32 v109, v61, v109, v29
  v_fma_f32 v110, v62, v110, v30
  v_fma_f32 v111, v63, v111, v31
  v_fma_f32 v112, v64, v112, v32
  v_fma_f32 v113, v65, v113, v33
  v_fma_f32 v114, v66, v114, v34
  v_fma_f32 v115, v67, v115, v35
  v_fma_f32 v116, v68, v116, v36
  v_fma_f32 v117, v69, v117, v37
  v_fma_f32 v118, v70, v118, v38
  v_fma_f32 v119, v71, v119, v39
  v_fma_f32 v120, v72, v120, v40
  v_fma_f32 v121, v73, v121, v41
  v_fma_f32 v122, v74, v122, v42
  v_fma_f32 v123, v75, v123, v43
  v_cvt_pk_bf16_f32 v124, v108, v109
  v_cvt_pk_bf16_f32 v125, v110, v111
  buffer_store_dwordx2 v[124:125], v203, s[16:19], 0 offen offset:0
  v_cvt_pk_bf16_f32 v126, v112, v113
  v_cvt_pk_bf16_f32 v127, v114, v115
  buffer_store_dwordx2 v[126:127], v203, s[16:19], 0 offen offset:16
  v_cvt_pk_bf16_f32 v128, v116, v117
  v_cvt_pk_bf16_f32 v129, v118, v119
  buffer_store_dwordx2 v[128:129], v203, s[16:19], 0 offen offset:32
  v_cvt_pk_bf16_f32 v130, v120, v121
  v_cvt_pk_bf16_f32 v131, v122, v123
  buffer_store_dwordx2 v[130:131], v203, s[16:19], 0 offen offset:48
  s_branch K2_FIN
K2_EPI_NOJOB:
  s_waitcnt lgkmcnt(0)
  s_barrier
  v_mul_f32 v108, v243, v29
  v_fmac_f32 v108, v244, v45
  v_mul_f32 v109, v243, v30
  v_fmac_f32 v109, v244, v46
  v_mul_f32 v110, v243, v31
  v_fmac_f32 v110, v244, v47
  v_mul_f32 v111, v243, v33
  v_fmac_f32 v111, v244, v49
  v_mul_f32 v112, v243, v34
  v_fmac_f32 v112, v244, v50
  v_mul_f32 v113, v243, v35
  v_fmac_f32 v113, v244, v51
  v_mul_f32 v114, v243, v37
  v_fmac_f32 v114, v244, v53
  v_mul_f32 v115, v243, v38
  v_fmac_f32 v115, v244, v54
  v_mul_f32 v116, v243, v39
  v_fmac_f32 v116, v244, v55
  v_mul_f32 v117, v243, v41
  v_fmac_f32 v117, v244, v57
  v_mul_f32 v118, v243, v42
  v_fmac_f32 v118, v244, v58
  v_mul_f32 v119, v243, v43
  v_fmac_f32 v119, v244, v59
  v_add_f32_dpp v108, v108, v108 row_shr:1 row_mask:0xf bank_mask:0xf bound_ctrl:0
  v_add_f32_dpp v109, v109, v109 row_shr:1 row_mask:0xf bank_mask:0xf bound_ctrl:0
  v_add_f32_dpp v110, v110, v110 row_shr:1 row_mask:0xf bank_mask:0xf bound_ctrl:0
  v_add_f32_dpp v111, v111, v111 row_shr:1 row_mask:0xf bank_mask:0xf bound_ctrl:0
  v_add_f32_dpp v112, v112, v112 row_shr:1 row_mask:0xf bank_mask:0xf bound_ctrl:0
  v_add_f32_dpp v113, v113, v113 row_shr:1 row_mask:0xf bank_mask:0xf bound_ctrl:0
  v_add_f32_dpp v114, v114, v114 row_shr:1 row_mask:0xf bank_mask:0xf bound_ctrl:0
  v_add_f32_dpp v115, v115, v115 row_shr:1 row_mask:0xf bank_mask:0xf bound_ctrl:0
  v_add_f32_dpp v116, v116, v116 row_shr:1 row_mask:0xf bank_mask:0xf bound_ctrl:0
  v_add_f32_dpp v117, v117, v117 row_shr:1 row_mask:0xf bank_mask:0xf bound_ctrl:0
  v_add_f32_dpp v118, v118, v118 row_shr:1 row_mask:0xf bank_mask:0xf bound_ctrl:0
  v_add_f32_dpp v119, v119, v119 row_shr:1 row_mask:0xf bank_mask:0xf bound_ctrl:0
  v_add_f32_dpp v108, v108, v108 row_shr:2 row_mask:0xf bank_mask:0xf bound_ctrl:0
  v_add_f32_dpp v109, v109, v109 row_shr:2 row_mask:0xf bank_mask:0xf bound_ctrl:0
  v_add_f32_dpp v110, v110, v110 row_shr:2 row_mask:0xf bank_mask:0xf bound_ctrl:0
  v_add_f32_dpp v111, v111, v111 row_shr:2 row_mask:0xf bank_mask:0xf bound_ctrl:0
  v_add_f32_dpp v112, v112, v112 row_shr:2 row_mask:0xf bank_mask:0xf bound_ctrl:0
  v_add_f32_dpp v113, v113, v113 row_shr:2 row_mask:0xf bank_mask:0xf bound_ctrl:0
  v_add_f32_dpp v114, v114, v114 row_shr:2 row_mask:0xf bank_mask:0xf bound_ctrl:0
  v_add_f32_dpp v115, v115, v115 row_shr:2 row_mask:0xf bank_mask:0xf bound_ctrl:0
  v_add_f32_dpp v116, v116, v116 row_shr:2 row_mask:0xf bank_mask:0xf bound_ctrl:0
  v_add_f32_dpp v117, v117, v117 row_shr:2 row_mask:0xf bank_mask:0xf bound_ctrl:0
  v_add_f32_dpp v118, v118, v118 row_shr:2 row_mask:0xf bank_mask:0xf bound_ctrl:0
  v_add_f32_dpp v119, v119, v119 row_shr:2 row_mask:0xf bank_mask:0xf bound_ctrl:0
  v_add_f32_dpp v108, v108, v108 row_shr:4 row_mask:0xf bank_mask:0xf bound_ctrl:0
  v_add_f32_dpp v109, v109, v109 row_shr:4 row_mask:0xf bank_mask:0xf bound_ctrl:0
  v_add_f32_dpp v110, v110, v110 row_shr:4 row_mask:0xf bank_mask:0xf bound_ctrl:0
  v_add_f32_dpp v111, v111, v111 row_shr:4 row_mask:0xf bank_mask:0xf bound_ctrl:0
  v_add_f32_dpp v112, v112, v112 row_shr:4 row_mask:0xf bank_mask:0xf bound_ctrl:0
  v_add_f32_dpp v113, v113, v113 row_shr:4 row_mask:0xf bank_mask:0xf bound_ctrl:0
  v_add_f32_dpp v114, v114, v114 row_shr:4 row_mask:0xf bank_mask:0xf bound_ctrl:0
  v_add_f32_dpp v115, v115, v115 row_shr:4 row_mask:0xf bank_mask:0xf bound_ctrl:0
  v_add_f32_dpp v116, v116, v116 row_shr:4 row_mask:0xf bank_mask:0xf bound_ctrl:0
  v_add_f32_dpp v117, v117, v117 row_shr:4 row_mask:0xf bank_mask:0xf bound_ctrl:0
  v_add_f32_dpp v118, v118, v118 row_shr:4 row_mask:0xf bank_mask:0xf bound_ctrl:0
  v_add_f32_dpp v119, v119, v119 row_shr:4 row_mask:0xf bank_mask:0xf bound_ctrl:0
  v_add_f32_dpp v108, v108, v108 row_shr:8 row_mask:0xf bank_mask:0xf bound_ctrl:0
  v_add_f32_dpp v109, v109, v109 row_shr:8 row_mask:0xf bank_mask:0xf bound_ctrl:0
  v_add_f32_dpp v110, v110, v110 row_shr:8 row_mask:0xf bank_mask:0xf bound_ctrl:0
  v_add_f32_dpp v111, v111, v111 row_shr:8 row_mask:0xf bank_mask:0xf bound_ctrl:0
  v_add_f32_dpp v112, v112, v112 row_shr:8 row_mask:0xf bank_mask:0xf bound_ctrl:0
  v_add_f32_dpp v113, v113, v113 row_shr:8 row_mask:0xf bank_mask:0xf bound_ctrl:0
  v_add_f32_dpp v114, v114, v114 row_shr:8 row_mask:0xf bank_mask:0xf bound_ctrl:0
  v_add_f32_dpp v115, v115, v115 row_shr:8 row_mask:0xf bank_mask:0xf bound_ctrl:0
  v_add_f32_dpp v116, v116, v116 row_shr:8 row_mask:0xf bank_mask:0xf bound_ctrl:0
  v_add_f32_dpp v117, v117, v117 row_shr:8 row_mask:0xf bank_mask:0xf bound_ctrl:0
  v_add_f32_dpp v118, v118, v118 row_shr:8 row_mask:0xf bank_mask:0xf bound_ctrl:0
  v_add_f32_dpp v119, v119, v119 row_shr:8 row_mask:0xf bank_mask:0xf bound_ctrl:0
  v_add_f32_dpp v108, v108, v108 row_bcast:15 row_mask:0xa bank_mask:0xf
  v_add_f32_dpp v109, v109, v109 row_bcast:15 row_mask:0xa bank_mask:0xf
  v_add_f32_dpp v110, v110, v110 row_bcast:15 row_mask:0xa bank_mask:0xf
  v_add_f32_dpp v111, v111, v111 row_bcast:15 row_mask:0xa bank_mask:0xf
  v_add_f32_dpp v112, v112, v112 row_bcast:15 row_mask:0xa bank_mask:0xf
  v_add_f32_dpp v113, v113, v113 row_bcast:15 row_mask:0xa bank_mask:0xf
  v_add_f32_dpp v114, v114, v114 row_bcast:15 row_mask:0xa bank_mask:0xf
  v_add_f32_dpp v115, v115, v115 row_bcast:15 row_mask:0xa bank_mask:0xf
  v_add_f32_dpp v116, v116, v116 row_bcast:15 row_mask:0xa bank_mask:0xf
  v_add_f32_dpp v117, v117, v117 row_bcast:15 row_mask:0xa bank_mask:0xf
  v_add_f32_dpp v118, v118, v118 row_bcast:15 row_mask:0xa bank_mask:0xf
  v_add_f32_dpp v119, v119, v119 row_bcast:15 row_mask:0xa bank_mask:0xf
  v_lshrrev_b32 v237, 5, v1
  v_lshlrev_b32 v237, 4, v237
  s_add_u32 s46, s62, 1024
  v_add_u32 v237, s46, v237
  s_mov_b32 exec_lo, 0x80000000
  s_mov_b32 exec_hi, 0x80000000
  ds_write_b32 v237, v108 offset:0
  ds_write_b32 v237, v109 offset:4
  ds_write_b32 v237, v110 offset:8
  ds_write_b32 v237, v111 offset:32
  ds_write_b32 v237, v112 offset:36
  ds_write_b32 v237, v113 offset:40
  ds_write_b32 v237, v114 offset:64
  ds_write_b32 v237, v115 offset:68
  ds_write_b32 v237, v116 offset:72
  ds_write_b32 v237, v117 offset:96
  ds_write_b32 v237, v118 offset:100
  ds_write_b32 v237, v119 offset:104
  s_mov_b64 exec, -1
  v_mul_u32_u24 v237, 86, v1
  v_lshrrev_b32 v237, 8, v237
  v_mul_u32_u24 v238, 3, v237
  v_sub_u32 v238, v1, v238
  v_lshlrev_b32 v237, 4, v237
  v_lshl_add_u32 v237, v238, 2, v237
  v_add_u32 v237, s46, v237
  v_min_u32 v237, 159996, v237
  ds_read_b32 v226, v237
  v_lshl_add_u32 v238, v1, 1, s35
  v_min_u32 v237, 75774, v238
  ds_read_u16_d16_hi v213, v237 offset:1280
  s_mul_i32 s46, s34, 3
  v_cmp_gt_u32 vcc, s46, v1
  v_add_u32 v238, 1600000, v238
  v_mov_b32 v237, 0x40000000
  s_waitcnt lgkmcnt(0)
  v_cndmask_b32 v238, v237, v238, vcc
  v_add_f32 v226, v226, v213
  v_cvt_pk_bf16_f32 v226, v226, v226
  buffer_store_short v226, v238, s[16:19], 0 offen
K2_FIN:
K_END:
  s_endpgm
K_CODE_END:
.section .rodata,"a"
.p2align 6
.amdhsa_kernel gather_scatter__cheap_equivariant_egnn__graph_kernel
  .amdhsa_next_free_vgpr 256
  .amdhsa_next_free_sgpr 102
  .amdhsa_accum_offset 256
  .amdhsa_group_segment_fixed_size 0
  .amdhsa_kernarg_size 88
  .amdhsa_user_sgpr_count 2
  .amdhsa_user_sgpr_kernarg_segment_ptr 1
  .amdhsa_system_sgpr_workgroup_id_x 1
  .amdhsa_float_denorm_mode_32 3
.end_amdhsa_kernel
```
